```python
import torch

def _softmax(x, axis=-1):
    return torch.softmax(x, dim=axis)
def _gelu(x):
    return torch.nn.functional.gelu(x, approximate="tanh")
def _silu(x):
    return torch.nn.functional.silu(x)
def _sigmoid(x):
    return torch.sigmoid(x)
def _layernorm(x, axis=-1, eps=1e-5):
    m = x.mean(dim=axis, keepdim=True)
    v = x.var(dim=axis, keepdim=True, unbiased=False)
    return (x - m) / torch.sqrt(v + eps)
def _scatter_add(tgt, idx, src, axis=0):
    return tgt.clone().index_add_(axis, idx, src)
def _segment_sum(src, seg, n):
    out = torch.zeros((n,) + src.shape[1:], dtype=src.dtype)
    return out.index_add_(0, seg, src)
def _pad(x, pw):
    flat = tuple(v for pair in reversed(pw) for v in pair)
    return torch.nn.functional.pad(x, flat)

kernel_name = 'concat_heads__gqa_block_cached__gqa_block_cached__near_ridge'

def setup_inputs():

    _w = (lambda a: (lambda t: t.to(torch.bfloat16) if t.is_floating_point() else t)(torch.as_tensor(a)))
    def _A_setup():
        B, Sq, D = 8, 64, 448
        Hq, Hkv, Sk, Dh = 16, 8, 1024, 256
        assert Hq % Hkv == 0, (Hq, Hkv)
        return {
            "x": _w((lambda *s: torch.randn(*s, dtype=torch.bfloat16) * 0.8)(B, Sq, D)),
            "k_cache": _w((lambda *s: torch.randn(*s, dtype=torch.bfloat16) * 0.8)(B, Hkv, Sk, Dh)),
            "v_cache": _w((lambda *s: torch.randn(*s, dtype=torch.bfloat16) * 0.05)(B, Hkv, Sk, Dh)),
            "wq": _w((lambda *s: torch.randn(*s, dtype=torch.bfloat16) * 0.8)(D, Hq * Dh) * (D ** -0.5)),
            "wo": _w((lambda *s: torch.randn(*s, dtype=torch.bfloat16) * 0.05)(Hq * Dh, D) * ((Hq * Dh) ** -0.5)),
        }
    _A_in = _A_setup()

    def _B_setup():
        B, Sq, D = 8, 64, 448
        Hq, Hkv, Sk, Dh = 16, 8, 1024, 256
        assert Hq % Hkv == 0, (Hq, Hkv)
        return {
            "x": _w((lambda *s: torch.randn(*s, dtype=torch.bfloat16) * 0.8)(B, Sq, D)),
            "k_cache": _w((lambda *s: torch.randn(*s, dtype=torch.bfloat16) * 0.8)(B, Hkv, Sk, Dh)),
            "v_cache": _w((lambda *s: torch.randn(*s, dtype=torch.bfloat16) * 0.05)(B, Hkv, Sk, Dh)),
            "wq": _w((lambda *s: torch.randn(*s, dtype=torch.bfloat16) * 0.8)(D, Hq * Dh) * (D ** -0.5)),
            "wo": _w((lambda *s: torch.randn(*s, dtype=torch.bfloat16) * 0.05)(Hq * Dh, D) * ((Hq * Dh) ** -0.5)),
        }
    _B_in = _B_setup()

    return {
        "A_x": _A_in["x"],
        "A_k_cache": _A_in["k_cache"],
        "A_v_cache": _A_in["v_cache"],
        "A_wq": _A_in["wq"],
        "A_wo": _A_in["wo"],
        "B_x": _B_in["x"],
        "B_k_cache": _B_in["k_cache"],
        "B_v_cache": _B_in["v_cache"],
        "B_wq": _B_in["wq"],
        "B_wo": _B_in["wo"],
    }

def reference(A_x, A_k_cache, A_v_cache, A_wq, A_wo, B_x, B_k_cache, B_v_cache, B_wq, B_wo):
    def _A_ref(x, k_cache, v_cache, wq, wo):
        B, Sq, D = x.shape
        Hq, Dh = 16, 256
        Hkv = k_cache.shape[1]
        rep = Hq // Hkv
        q = (lambda x, *d: x.permute(*d))((x @ wq).reshape(B, Sq, Hq, Dh), 0, 2, 1, 3)
        k = (lambda x, n, axis: torch.repeat_interleave(x, n, dim=axis))(k_cache, rep, axis=1)
        v = (lambda x, n, axis: torch.repeat_interleave(x, n, dim=axis))(v_cache, rep, axis=1)
        scores = torch.einsum("bhqd,bhkd->bhqk", q, k) * (Dh ** -0.5)
        p = _softmax(scores, axis=-1)
        o = torch.einsum("bhqk,bhkd->bhqd", p, v)
        return (lambda x, *d: x.permute(*d))(o, 0, 2, 1, 3).reshape(B, Sq, Hq * Dh) @ wo

    def _B_ref(x, k_cache, v_cache, wq, wo):
        B, Sq, D = x.shape
        Hq, Dh = 16, 256
        Hkv = k_cache.shape[1]
        rep = Hq // Hkv
        q = (lambda x, *d: x.permute(*d))((x @ wq).reshape(B, Sq, Hq, Dh), 0, 2, 1, 3)
        k = (lambda x, n, axis: torch.repeat_interleave(x, n, dim=axis))(k_cache, rep, axis=1)
        v = (lambda x, n, axis: torch.repeat_interleave(x, n, dim=axis))(v_cache, rep, axis=1)
        scores = torch.einsum("bhqd,bhkd->bhqk", q, k) * (Dh ** -0.5)
        p = _softmax(scores, axis=-1)
        o = torch.einsum("bhqk,bhkd->bhqd", p, v)
        return (lambda x, *d: x.permute(*d))(o, 0, 2, 1, 3).reshape(B, Sq, Hq * Dh) @ wo

    a = _A_ref(A_x, A_k_cache, A_v_cache, A_wq, A_wo)
    b = _B_ref(B_x, B_k_cache, B_v_cache, B_wq, B_wo)
    return torch.concatenate([a, b], axis=-1)
```

```asm
; @launch grid=(256,1,1) block=(512,1,1) lds=163840
.amdgcn_target "amdgcn-amd-amdhsa--gfx950"
.text
.globl concat_heads__gqa_block_cached__gqa_block_cached__near_ridge_kernel
.p2align 8
.type concat_heads__gqa_block_cached__gqa_block_cached__near_ridge_kernel,@function
concat_heads__gqa_block_cached__gqa_block_cached__near_ridge_kernel:
    s_cmp_ge_u32 s2, 256
    s_cbranch_scc1 L_end
    s_and_b32 s3, s2, 7
    s_lshr_b32 s4, s2, 3
    s_lshr_b32 s5, s3, 2
    s_mul_i32 s6, s5, 40
    s_add_u32 s6, s0, s6
    s_addc_u32 s7, s1, 0
    s_load_dwordx2 s[24:25], s[6:7], 0
    s_load_dwordx2 s[8:9], s[6:7], 24
    s_load_dwordx2 s[12:13], s[6:7], 8
    s_load_dwordx2 s[16:17], s[6:7], 16
    s_load_dwordx2 s[20:21], s[6:7], 32
    s_load_dwordx2 s[28:29], s[0:1], 96
    s_load_dwordx2 s[48:49], s[0:1], 88
    s_load_dwordx2 s[52:53], s[0:1], 80
    s_and_b32 s3, s3, 3
    s_lshl_b32 s3, s3, 2
    s_and_b32 s6, s4, 3
    s_add_u32 s3, s3, s6
    s_lshr_b32 s4, s4, 2
    v_lshrrev_b32 v232, 6, v0
    v_and_b32 v233, 63, v0
    v_readfirstlane_b32 s32, v232
    v_lshrrev_b32 v234, 5, v233
    v_and_b32 v235, 31, v0
    v_lshlrev_b32 v227, 4, v233
    s_lshl_b32 s7, s5, 3
    s_add_u32 s5, s7, s4
    s_lshr_b32 s60, s6, 1
    s_mul_i32 s60, s60, 3
    s_add_u32 s60, s60, s4
    s_sub_u32 s7, s60, 7
    s_cmp_ge_u32 s60, 7
    s_cselect_b32 s60, s7, s60
    s_cmp_eq_u32 s4, 7
    s_cselect_b32 s61, 0, s4
    s_cmp_ge_u32 s32, 4
    s_cbranch_scc1 L_compute
    s_mul_i32 s37, s4, 57344
    s_lshl_b32 s38, s3, 9
    s_mov_b32 s26, 57344
    s_mov_b32 s27, 0x20000
    s_sub_u32 s10, 3670016, s38
    s_mov_b32 s11, 0x20000
    v_lshrrev_b32 v240, 4, v233
    v_lshrrev_b32 v236, 3, v233
    v_and_b32 v237, 7, v233
    v_mul_u32_u24 v236, 896, v236
    v_add_u32 v238, 0, v240
    v_xor_b32 v238, v238, v237
    v_lshl_add_u32 v190, v238, 4, v236
    v_add_u32 v238, 4, v240
    v_xor_b32 v238, v238, v237
    v_lshl_add_u32 v191, v238, 4, v236
    v_add_u32 v191, 6144, v191
    v_mul_u32_u24 v239, 7680, v234
    v_add_u32 v238, 0, v234
    v_lshlrev_b32 v238, 2, v238
    v_xor_b32 v238, v238, v235
    v_lshlrev_b32 v238, 4, v238
    v_lshl_add_u32 v186, v234, 9, v238
    v_add_u32 v188, v239, v186
    v_add_u32 v238, 2, v234
    v_lshlrev_b32 v238, 2, v238
    v_xor_b32 v238, v238, v235
    v_lshlrev_b32 v238, 4, v238
    v_lshl_add_u32 v187, v234, 9, v238
    v_add_u32 v189, v239, v187
    v_add_u32 v189, 15360, v189
    s_lshl_b32 s42, s32, 11
    s_lshl_b32 s43, s32, 15
    s_lshl_b32 s6, s60, 19
    s_add_u32 s43, s43, s6
    s_mul_i32 s44, s32, 14336
    s_lshl_b32 s6, s60, 7
    s_add_u32 s44, s44, s6
    s_mov_b32 s34, s42
    s_add_u32 s63, s42, 131072
    s_waitcnt lgkmcnt(0)
    s_add_u32 s24, s24, s37
    s_addc_u32 s25, s25, 0
    s_add_u32 s8, s8, s38
    s_addc_u32 s9, s9, 0
    s_call_b64 s[40:41], L_issq
    s_lshr_b32 s6, s3, 1
    s_lshl_b32 s7, s4, 3
    s_add_u32 s6, s6, s7
    s_lshl_b32 s6, s6, 19
    s_add_u32 s12, s12, s6
    s_addc_u32 s13, s13, 0
    s_mov_b32 s14, 524288
    s_mov_b32 s15, 0x20000
    s_add_u32 s16, s16, s6
    s_addc_u32 s17, s17, 0
    s_mov_b32 s18, 524288
    s_mov_b32 s19, 0x20000
    s_mul_i32 s7, s3, 229376
    s_add_u32 s20, s20, s7
    s_addc_u32 s21, s21, 0
    s_mov_b32 s22, 229376
    s_mov_b32 s23, 0x20000
    v_lshl_add_u32 v238, v232, 2, v234
    v_add_u32 v239, 0, v238
    v_xor_b32 v239, v239, v235
    v_lshlrev_b32 v239, 4, v239
    v_lshl_add_u32 v184, v234, 9, v239
    v_add_u32 v239, 2, v238
    v_xor_b32 v239, v239, v235
    v_lshlrev_b32 v239, 4, v239
    v_lshl_add_u32 v185, v234, 9, v239
    v_and_b32 v238, 1, v240
    v_lshlrev_b32 v238, 2, v238
    v_xor_b32 v238, v238, v237
    v_lshl_add_u32 v192, v238, 4, v236
    s_mul_i32 s45, s32, 57344
    s_lshl_b32 s6, s61, 7
    s_add_u32 s45, s45, s6
    s_mov_b32 s36, s42
    s_call_b64 s[40:41], L_issq
    s_waitcnt vmcnt(10)
    s_barrier
    s_call_b64 s[40:41], L_issq
    s_waitcnt vmcnt(10)
    s_barrier
    s_call_b64 s[40:41], L_issq
    s_waitcnt vmcnt(10)
    s_barrier
    s_call_b64 s[40:41], L_issq
    s_waitcnt vmcnt(10)
    s_barrier
    s_call_b64 s[40:41], L_issq
    s_waitcnt vmcnt(10)
    s_barrier
    s_call_b64 s[40:41], L_issq
    s_waitcnt vmcnt(10)
    s_barrier
    s_call_b64 s[40:41], L_issk
    s_waitcnt vmcnt(8)
    s_barrier
    s_call_b64 s[40:41], L_issv
    s_barrier
    s_call_b64 s[40:41], L_issk
    s_waitcnt vmcnt(16)
    s_barrier
    s_call_b64 s[40:41], L_issv
    s_mov_b32 s35, 14
L_lloop:
    s_waitcnt vmcnt(16)
    s_barrier
    s_call_b64 s[40:41], L_issk
    s_waitcnt vmcnt(16)
    s_barrier
    s_call_b64 s[40:41], L_issv
    s_sub_u32 s35, s35, 1
    s_cmp_lg_u32 s35, 0
    s_cbranch_scc1 L_lloop
    s_waitcnt vmcnt(16)
    s_barrier
    s_call_b64 s[40:41], L_isswo
    s_waitcnt vmcnt(16)
    s_barrier
    s_call_b64 s[40:41], L_isswo
    s_waitcnt vmcnt(16)
    s_barrier
    s_call_b64 s[40:41], L_isswo
    s_waitcnt vmcnt(16)
    s_barrier
    s_call_b64 s[40:41], L_isswo
    s_waitcnt vmcnt(16)
    s_barrier
    s_add_u32 s34, s42, 131072
    s_call_b64 s[40:41], L_isswo
    s_waitcnt vmcnt(16)
    s_barrier
    s_add_u32 s34, s42, 98304
    s_call_b64 s[40:41], L_isswo
    s_waitcnt vmcnt(16)
    s_barrier
    s_call_b64 s[40:41], L_isswo
    s_waitcnt vmcnt(16)
    s_barrier
    s_mul_i32 s6, s5, 917504
    s_add_u32 s56, s28, 33554432
    s_addc_u32 s57, s29, 0
    s_mov_b32 s58, 65536
    s_mov_b32 s59, 0x20000
    s_add_u32 s28, s28, s6
    s_addc_u32 s29, s29, 0
    s_mov_b32 s30, 917504
    s_mov_b32 s31, 0x20000
    s_mov_b32 s54, 917504
    s_mov_b32 s55, 0x20000
    s_lshl_b32 s47, s3, 2
    s_add_u32 s47, s47, s32
    s_lshl_b32 s46, s47, 10
    s_and_b32 s6, s3, 1
    s_lshl_b32 s6, s6, 5
    s_lshl_b32 s7, s4, 6
    s_add_u32 s6, s6, s7
    s_mul_i32 s6, s6, 1792
    s_lshr_b32 s7, s5, 3
    s_mul_i32 s7, s7, 896
    s_add_u32 s6, s6, s7
    s_lshr_b32 s7, s3, 1
    s_lshl_b32 s7, s7, 7
    s_add_u32 s6, s6, s7
    s_lshl_b32 s7, s32, 5
    s_add_u32 s36, s6, s7
    v_mul_u32_u24 v236, 1792, v235
    v_lshl_add_u32 v236, v234, 3, v236
    s_lshl_b32 s6, s5, 4
    s_add_u32 s6, s6, s3
    s_lshl_b32 s6, s6, 8
    s_lshr_b32 s7, s32, 1
    s_lshl_b32 s7, s7, 6
    s_add_u32 s38, s6, s7
    v_and_b32 v237, 15, v233
    v_lshlrev_b32 v237, 2, v237
    s_waitcnt vmcnt(8)
    s_barrier
    s_waitcnt vmcnt(0)
    s_barrier
    s_cmp_ge_u32 s47, 56
    s_cbranch_scc1 L_lend
    s_mov_b32 s35, 0
L_poll:
    buffer_load_dword v238, v237, s[56:59], s38 offen sc1
    s_add_u32 s35, s35, 1
    s_waitcnt vmcnt(0)
    v_cmp_eq_u32 vcc, 0, v238
    s_cmp_gt_u32 s35, 100000
    s_cbranch_scc1 L_polled
    s_cbranch_vccz L_polled
    s_branch L_poll
L_polled:
L_rload:
    s_mov_b32 s37, s46
    buffer_load_dwordx4 v[0:3], v227, s[28:31], s37 offen sc1
    s_add_u32 s37, s37, 57344
    buffer_load_dwordx4 v[4:7], v227, s[28:31], s37 offen sc1
    s_add_u32 s37, s37, 57344
    buffer_load_dwordx4 v[8:11], v227, s[28:31], s37 offen sc1
    s_add_u32 s37, s37, 57344
    buffer_load_dwordx4 v[12:15], v227, s[28:31], s37 offen sc1
    s_add_u32 s37, s37, 57344
    buffer_load_dwordx4 v[16:19], v227, s[28:31], s37 offen sc1
    s_add_u32 s37, s37, 57344
    buffer_load_dwordx4 v[20:23], v227, s[28:31], s37 offen sc1
    s_add_u32 s37, s37, 57344
    buffer_load_dwordx4 v[24:27], v227, s[28:31], s37 offen sc1
    s_add_u32 s37, s37, 57344
    buffer_load_dwordx4 v[28:31], v227, s[28:31], s37 offen sc1
    s_add_u32 s37, s37, 57344
    buffer_load_dwordx4 v[32:35], v227, s[28:31], s37 offen sc1
    s_add_u32 s37, s37, 57344
    buffer_load_dwordx4 v[36:39], v227, s[28:31], s37 offen sc1
    s_add_u32 s37, s37, 57344
    buffer_load_dwordx4 v[40:43], v227, s[28:31], s37 offen sc1
    s_add_u32 s37, s37, 57344
    buffer_load_dwordx4 v[44:47], v227, s[28:31], s37 offen sc1
    s_add_u32 s37, s37, 57344
    buffer_load_dwordx4 v[48:51], v227, s[28:31], s37 offen sc1
    s_add_u32 s37, s37, 57344
    buffer_load_dwordx4 v[52:55], v227, s[28:31], s37 offen sc1
    s_add_u32 s37, s37, 57344
    buffer_load_dwordx4 v[56:59], v227, s[28:31], s37 offen sc1
    s_add_u32 s37, s37, 57344
    buffer_load_dwordx4 v[60:63], v227, s[28:31], s37 offen sc1
    s_waitcnt vmcnt(15)
    v_lshlrev_b32 v64, 16, v0
    v_and_b32 v65, 0xffff0000, v0
    v_lshlrev_b32 v66, 16, v1
    v_and_b32 v67, 0xffff0000, v1
    v_lshlrev_b32 v68, 16, v2
    v_and_b32 v69, 0xffff0000, v2
    v_lshlrev_b32 v70, 16, v3
    v_and_b32 v71, 0xffff0000, v3
    s_waitcnt vmcnt(14)
    v_lshlrev_b32 v72, 16, v4
    v_and_b32 v73, 0xffff0000, v4
    v_add_f32 v64, v64, v72
    v_add_f32 v65, v65, v73
    v_lshlrev_b32 v72, 16, v5
    v_and_b32 v73, 0xffff0000, v5
    v_add_f32 v66, v66, v72
    v_add_f32 v67, v67, v73
    v_lshlrev_b32 v72, 16, v6
    v_and_b32 v73, 0xffff0000, v6
    v_add_f32 v68, v68, v72
    v_add_f32 v69, v69, v73
    v_lshlrev_b32 v72, 16, v7
    v_and_b32 v73, 0xffff0000, v7
    v_add_f32 v70, v70, v72
    v_add_f32 v71, v71, v73
    s_waitcnt vmcnt(13)
    v_lshlrev_b32 v72, 16, v8
    v_and_b32 v73, 0xffff0000, v8
    v_add_f32 v64, v64, v72
    v_add_f32 v65, v65, v73
    v_lshlrev_b32 v72, 16, v9
    v_and_b32 v73, 0xffff0000, v9
    v_add_f32 v66, v66, v72
    v_add_f32 v67, v67, v73
    v_lshlrev_b32 v72, 16, v10
    v_and_b32 v73, 0xffff0000, v10
    v_add_f32 v68, v68, v72
    v_add_f32 v69, v69, v73
    v_lshlrev_b32 v72, 16, v11
    v_and_b32 v73, 0xffff0000, v11
    v_add_f32 v70, v70, v72
    v_add_f32 v71, v71, v73
    s_waitcnt vmcnt(12)
    v_lshlrev_b32 v72, 16, v12
    v_and_b32 v73, 0xffff0000, v12
    v_add_f32 v64, v64, v72
    v_add_f32 v65, v65, v73
    v_lshlrev_b32 v72, 16, v13
    v_and_b32 v73, 0xffff0000, v13
    v_add_f32 v66, v66, v72
    v_add_f32 v67, v67, v73
    v_lshlrev_b32 v72, 16, v14
    v_and_b32 v73, 0xffff0000, v14
    v_add_f32 v68, v68, v72
    v_add_f32 v69, v69, v73
    v_lshlrev_b32 v72, 16, v15
    v_and_b32 v73, 0xffff0000, v15
    v_add_f32 v70, v70, v72
    v_add_f32 v71, v71, v73
    s_waitcnt vmcnt(11)
    v_lshlrev_b32 v72, 16, v16
    v_and_b32 v73, 0xffff0000, v16
    v_add_f32 v64, v64, v72
    v_add_f32 v65, v65, v73
    v_lshlrev_b32 v72, 16, v17
    v_and_b32 v73, 0xffff0000, v17
    v_add_f32 v66, v66, v72
    v_add_f32 v67, v67, v73
    v_lshlrev_b32 v72, 16, v18
    v_and_b32 v73, 0xffff0000, v18
    v_add_f32 v68, v68, v72
    v_add_f32 v69, v69, v73
    v_lshlrev_b32 v72, 16, v19
    v_and_b32 v73, 0xffff0000, v19
    v_add_f32 v70, v70, v72
    v_add_f32 v71, v71, v73
    s_waitcnt vmcnt(10)
    v_lshlrev_b32 v72, 16, v20
    v_and_b32 v73, 0xffff0000, v20
    v_add_f32 v64, v64, v72
    v_add_f32 v65, v65, v73
    v_lshlrev_b32 v72, 16, v21
    v_and_b32 v73, 0xffff0000, v21
    v_add_f32 v66, v66, v72
    v_add_f32 v67, v67, v73
    v_lshlrev_b32 v72, 16, v22
    v_and_b32 v73, 0xffff0000, v22
    v_add_f32 v68, v68, v72
    v_add_f32 v69, v69, v73
    v_lshlrev_b32 v72, 16, v23
    v_and_b32 v73, 0xffff0000, v23
    v_add_f32 v70, v70, v72
    v_add_f32 v71, v71, v73
    s_waitcnt vmcnt(9)
    v_lshlrev_b32 v72, 16, v24
    v_and_b32 v73, 0xffff0000, v24
    v_add_f32 v64, v64, v72
    v_add_f32 v65, v65, v73
    v_lshlrev_b32 v72, 16, v25
    v_and_b32 v73, 0xffff0000, v25
    v_add_f32 v66, v66, v72
    v_add_f32 v67, v67, v73
    v_lshlrev_b32 v72, 16, v26
    v_and_b32 v73, 0xffff0000, v26
    v_add_f32 v68, v68, v72
    v_add_f32 v69, v69, v73
    v_lshlrev_b32 v72, 16, v27
    v_and_b32 v73, 0xffff0000, v27
    v_add_f32 v70, v70, v72
    v_add_f32 v71, v71, v73
    s_waitcnt vmcnt(8)
    v_lshlrev_b32 v72, 16, v28
    v_and_b32 v73, 0xffff0000, v28
    v_add_f32 v64, v64, v72
    v_add_f32 v65, v65, v73
    v_lshlrev_b32 v72, 16, v29
    v_and_b32 v73, 0xffff0000, v29
    v_add_f32 v66, v66, v72
    v_add_f32 v67, v67, v73
    v_lshlrev_b32 v72, 16, v30
    v_and_b32 v73, 0xffff0000, v30
    v_add_f32 v68, v68, v72
    v_add_f32 v69, v69, v73
    v_lshlrev_b32 v72, 16, v31
    v_and_b32 v73, 0xffff0000, v31
    v_add_f32 v70, v70, v72
    v_add_f32 v71, v71, v73
    s_waitcnt vmcnt(7)
    v_lshlrev_b32 v72, 16, v32
    v_and_b32 v73, 0xffff0000, v32
    v_add_f32 v64, v64, v72
    v_add_f32 v65, v65, v73
    v_lshlrev_b32 v72, 16, v33
    v_and_b32 v73, 0xffff0000, v33
    v_add_f32 v66, v66, v72
    v_add_f32 v67, v67, v73
    v_lshlrev_b32 v72, 16, v34
    v_and_b32 v73, 0xffff0000, v34
    v_add_f32 v68, v68, v72
    v_add_f32 v69, v69, v73
    v_lshlrev_b32 v72, 16, v35
    v_and_b32 v73, 0xffff0000, v35
    v_add_f32 v70, v70, v72
    v_add_f32 v71, v71, v73
    s_waitcnt vmcnt(6)
    v_lshlrev_b32 v72, 16, v36
    v_and_b32 v73, 0xffff0000, v36
    v_add_f32 v64, v64, v72
    v_add_f32 v65, v65, v73
    v_lshlrev_b32 v72, 16, v37
    v_and_b32 v73, 0xffff0000, v37
    v_add_f32 v66, v66, v72
    v_add_f32 v67, v67, v73
    v_lshlrev_b32 v72, 16, v38
    v_and_b32 v73, 0xffff0000, v38
    v_add_f32 v68, v68, v72
    v_add_f32 v69, v69, v73
    v_lshlrev_b32 v72, 16, v39
    v_and_b32 v73, 0xffff0000, v39
    v_add_f32 v70, v70, v72
    v_add_f32 v71, v71, v73
    s_waitcnt vmcnt(5)
    v_lshlrev_b32 v72, 16, v40
    v_and_b32 v73, 0xffff0000, v40
    v_add_f32 v64, v64, v72
    v_add_f32 v65, v65, v73
    v_lshlrev_b32 v72, 16, v41
    v_and_b32 v73, 0xffff0000, v41
    v_add_f32 v66, v66, v72
    v_add_f32 v67, v67, v73
    v_lshlrev_b32 v72, 16, v42
    v_and_b32 v73, 0xffff0000, v42
    v_add_f32 v68, v68, v72
    v_add_f32 v69, v69, v73
    v_lshlrev_b32 v72, 16, v43
    v_and_b32 v73, 0xffff0000, v43
    v_add_f32 v70, v70, v72
    v_add_f32 v71, v71, v73
    s_waitcnt vmcnt(4)
    v_lshlrev_b32 v72, 16, v44
    v_and_b32 v73, 0xffff0000, v44
    v_add_f32 v64, v64, v72
    v_add_f32 v65, v65, v73
    v_lshlrev_b32 v72, 16, v45
    v_and_b32 v73, 0xffff0000, v45
    v_add_f32 v66, v66, v72
    v_add_f32 v67, v67, v73
    v_lshlrev_b32 v72, 16, v46
    v_and_b32 v73, 0xffff0000, v46
    v_add_f32 v68, v68, v72
    v_add_f32 v69, v69, v73
    v_lshlrev_b32 v72, 16, v47
    v_and_b32 v73, 0xffff0000, v47
    v_add_f32 v70, v70, v72
    v_add_f32 v71, v71, v73
    s_waitcnt vmcnt(3)
    v_lshlrev_b32 v72, 16, v48
    v_and_b32 v73, 0xffff0000, v48
    v_add_f32 v64, v64, v72
    v_add_f32 v65, v65, v73
    v_lshlrev_b32 v72, 16, v49
    v_and_b32 v73, 0xffff0000, v49
    v_add_f32 v66, v66, v72
    v_add_f32 v67, v67, v73
    v_lshlrev_b32 v72, 16, v50
    v_and_b32 v73, 0xffff0000, v50
    v_add_f32 v68, v68, v72
    v_add_f32 v69, v69, v73
    v_lshlrev_b32 v72, 16, v51
    v_and_b32 v73, 0xffff0000, v51
    v_add_f32 v70, v70, v72
    v_add_f32 v71, v71, v73
    s_waitcnt vmcnt(2)
    v_lshlrev_b32 v72, 16, v52
    v_and_b32 v73, 0xffff0000, v52
    v_add_f32 v64, v64, v72
    v_add_f32 v65, v65, v73
    v_lshlrev_b32 v72, 16, v53
    v_and_b32 v73, 0xffff0000, v53
    v_add_f32 v66, v66, v72
    v_add_f32 v67, v67, v73
    v_lshlrev_b32 v72, 16, v54
    v_and_b32 v73, 0xffff0000, v54
    v_add_f32 v68, v68, v72
    v_add_f32 v69, v69, v73
    v_lshlrev_b32 v72, 16, v55
    v_and_b32 v73, 0xffff0000, v55
    v_add_f32 v70, v70, v72
    v_add_f32 v71, v71, v73
    s_waitcnt vmcnt(1)
    v_lshlrev_b32 v72, 16, v56
    v_and_b32 v73, 0xffff0000, v56
    v_add_f32 v64, v64, v72
    v_add_f32 v65, v65, v73
    v_lshlrev_b32 v72, 16, v57
    v_and_b32 v73, 0xffff0000, v57
    v_add_f32 v66, v66, v72
    v_add_f32 v67, v67, v73
    v_lshlrev_b32 v72, 16, v58
    v_and_b32 v73, 0xffff0000, v58
    v_add_f32 v68, v68, v72
    v_add_f32 v69, v69, v73
    v_lshlrev_b32 v72, 16, v59
    v_and_b32 v73, 0xffff0000, v59
    v_add_f32 v70, v70, v72
    v_add_f32 v71, v71, v73
    s_waitcnt vmcnt(0)
    v_lshlrev_b32 v72, 16, v60
    v_and_b32 v73, 0xffff0000, v60
    v_add_f32 v64, v64, v72
    v_add_f32 v65, v65, v73
    v_lshlrev_b32 v72, 16, v61
    v_and_b32 v73, 0xffff0000, v61
    v_add_f32 v66, v66, v72
    v_add_f32 v67, v67, v73
    v_lshlrev_b32 v72, 16, v62
    v_and_b32 v73, 0xffff0000, v62
    v_add_f32 v68, v68, v72
    v_add_f32 v69, v69, v73
    v_lshlrev_b32 v72, 16, v63
    v_and_b32 v73, 0xffff0000, v63
    v_add_f32 v70, v70, v72
    v_add_f32 v71, v71, v73
L_rdone:
    v_cvt_pk_bf16_f32 v74, v64, v65
    v_cvt_pk_bf16_f32 v75, v66, v67
    v_cvt_pk_bf16_f32 v76, v68, v69
    v_cvt_pk_bf16_f32 v77, v70, v71
    buffer_store_dwordx2 v[74:75], v236, s[52:55], s36 offen
    buffer_store_dwordx2 v[76:77], v236, s[52:55], s36 offen offset:16
L_lend:
L_end:
    s_endpgm
L_issq:
    s_mov_b32 m0, s63
    s_nop 0
    buffer_load_dwordx4 v190, s[24:27], s44 offen offset:0 lds
    buffer_load_dwordx4 v191, s[24:27], s44 offen offset:1024 lds
    s_add_u32 m0, s34, 0
    s_add_u32 s37, s43, 0
    buffer_load_dwordx4 v188, s[8:11], s37 offen offset:0 lds
    buffer_load_dwordx4 v189, s[8:11], s37 offen offset:1024 lds
    s_add_u32 m0, s34, 8192
    s_add_u32 s37, s43, 131072
    buffer_load_dwordx4 v188, s[8:11], s37 offen offset:0 lds
    buffer_load_dwordx4 v189, s[8:11], s37 offen offset:1024 lds
    s_add_u32 m0, s34, 16384
    s_add_u32 s37, s43, 262144
    buffer_load_dwordx4 v188, s[8:11], s37 offen offset:0 lds
    buffer_load_dwordx4 v189, s[8:11], s37 offen offset:1024 lds
    s_add_u32 m0, s34, 24576
    s_add_u32 s37, s43, 393216
    buffer_load_dwordx4 v188, s[8:11], s37 offen offset:0 lds
    buffer_load_dwordx4 v189, s[8:11], s37 offen offset:1024 lds
    s_add_u32 s44, s44, 128
    s_add_u32 s43, s43, 524288
    s_add_u32 s60, s60, 1
    s_cmp_lt_u32 s60, 7
    s_cbranch_scc1 L_issq_nw
    s_sub_u32 s44, s44, 896
    s_sub_u32 s43, s43, 3670016
    s_mov_b32 s60, 0
L_issq_nw:
    s_add_u32 s63, s63, 8192
    s_and_b32 s63, s63, 0x27fff
    s_add_u32 s34, s34, 32768
    s_and_b32 s34, s34, 0x1ffff
    s_setpc_b64 s[40:41]
L_issk:
    s_mov_b32 m0, s34
    s_nop 0
    buffer_load_dwordx4 v184, s[12:15], s36 offen offset:0 nt lds
    buffer_load_dwordx4 v185, s[12:15], s36 offen offset:1024 nt lds
    s_add_u32 m0, m0, 8192
    s_add_u32 s37, s36, 8192
    buffer_load_dwordx4 v184, s[12:15], s37 offen offset:0 nt lds
    buffer_load_dwordx4 v185, s[12:15], s37 offen offset:1024 nt lds
    s_add_u32 m0, m0, 8192
    s_add_u32 s37, s36, 16384
    buffer_load_dwordx4 v184, s[12:15], s37 offen offset:0 nt lds
    buffer_load_dwordx4 v185, s[12:15], s37 offen offset:1024 nt lds
    s_add_u32 m0, m0, 8192
    s_add_u32 s37, s36, 24576
    buffer_load_dwordx4 v184, s[12:15], s37 offen offset:0 nt lds
    buffer_load_dwordx4 v185, s[12:15], s37 offen offset:1024 nt lds
    s_add_u32 s34, s34, 32768
    s_and_b32 s34, s34, 0x1ffff
    s_setpc_b64 s[40:41]
L_issv:
    s_mov_b32 m0, s34
    s_nop 0
    buffer_load_dwordx4 v186, s[16:19], s36 offen offset:0 nt lds
    buffer_load_dwordx4 v187, s[16:19], s36 offen offset:1024 nt lds
    s_add_u32 m0, m0, 8192
    s_add_u32 s37, s36, 8192
    buffer_load_dwordx4 v186, s[16:19], s37 offen offset:0 nt lds
    buffer_load_dwordx4 v187, s[16:19], s37 offen offset:1024 nt lds
    s_add_u32 m0, m0, 8192
    s_add_u32 s37, s36, 16384
    buffer_load_dwordx4 v186, s[16:19], s37 offen offset:0 nt lds
    buffer_load_dwordx4 v187, s[16:19], s37 offen offset:1024 nt lds
    s_add_u32 m0, m0, 8192
    s_add_u32 s37, s36, 24576
    buffer_load_dwordx4 v186, s[16:19], s37 offen offset:0 nt lds
    buffer_load_dwordx4 v187, s[16:19], s37 offen offset:1024 nt lds
    s_add_u32 s34, s34, 32768
    s_and_b32 s34, s34, 0x1ffff
    s_add_u32 s36, s36, 32768
    s_setpc_b64 s[40:41]
L_isswo:
    s_mul_i32 s37, s42, 3
    s_add_u32 m0, s34, s37
    s_mov_b32 s37, s45
    buffer_load_dwordx4 v192, s[20:23], s37 offen lds
    s_add_u32 m0, m0, 1024
    s_add_u32 s37, s37, 7168
    buffer_load_dwordx4 v192, s[20:23], s37 offen lds
    s_add_u32 m0, m0, 1024
    s_add_u32 s37, s37, 7168
    buffer_load_dwordx4 v192, s[20:23], s37 offen lds
    s_add_u32 m0, m0, 1024
    s_add_u32 s37, s37, 7168
    buffer_load_dwordx4 v192, s[20:23], s37 offen lds
    s_add_u32 m0, m0, 1024
    s_add_u32 s37, s37, 7168
    buffer_load_dwordx4 v192, s[20:23], s37 offen lds
    s_add_u32 m0, m0, 1024
    s_add_u32 s37, s37, 7168
    buffer_load_dwordx4 v192, s[20:23], s37 offen lds
    s_add_u32 m0, m0, 1024
    s_add_u32 s37, s37, 7168
    buffer_load_dwordx4 v192, s[20:23], s37 offen lds
    s_add_u32 m0, m0, 1024
    s_add_u32 s37, s37, 7168
    buffer_load_dwordx4 v192, s[20:23], s37 offen lds
    s_add_u32 s45, s45, 128
    s_add_u32 s61, s61, 1
    s_cmp_lt_u32 s61, 7
    s_cbranch_scc1 L_isswo_nw
    s_sub_u32 s45, s45, 896
    s_mov_b32 s61, 0
L_isswo_nw:
    s_add_u32 s34, s34, 32768
    s_and_b32 s34, s34, 0x1ffff
    s_setpc_b64 s[40:41]
L_compute:
    s_setprio 2
    s_sub_u32 s32, s32, 4
    s_cmp_ge_u32 s32, 3
    s_cbranch_scc1 L_nocpf
    s_cmp_ge_u32 s2, 64
    s_cbranch_scc1 L_nocpf
    s_getpc_b64 s[92:93]
L_pcref:
    s_sub_u32 s92, s92, L_pcref-concat_heads__gqa_block_cached__gqa_block_cached__near_ridge_kernel
    s_subb_u32 s93, s93, 0
    s_mov_b32 s94, L_codeend-concat_heads__gqa_block_cached__gqa_block_cached__near_ridge_kernel
    s_mov_b32 s95, 0x20000
    v_lshlrev_b32 v236, 3, v227
    s_lshl_b32 s6, s32, 13
    buffer_load_dword v246, v236, s[92:95], s6 offen
L_nocpf:
    s_and_b32 s62, s32, 1
    s_lshr_b32 s47, s32, 1
    s_mov_b32 s50, 256
    s_mov_b32 s51, 0x20000
    s_mov_b32 s58, 65536
    s_mov_b32 s59, 0x20000
    s_lshl_b32 s6, s5, 4
    s_add_u32 s6, s6, s3
    s_lshl_b32 s37, s6, 8
    s_mul_i32 s6, s6, 57344
    v_lshlrev_b32 v236, 2, v235
    v_mov_b32 v237, 0
    v_mov_b32 v229, 1
    s_lshl_b32 s7, s5, 4
    v_mov_b32 v238, s7
    s_waitcnt lgkmcnt(0)
    s_add_u32 s56, s28, 33554432
    s_addc_u32 s57, s29, 0
    s_add_u32 s28, s28, s6
    s_addc_u32 s29, s29, 0
    s_mov_b32 s30, 57344
    s_mov_b32 s31, 0x20000
    s_cmp_lg_u32 s32, 0
    s_cbranch_scc1 L_noclr
    buffer_store_dword v237, v236, s[56:59], s37 offen sc1
    s_waitcnt vmcnt(0)
    s_mov_b64 exec, 1
    buffer_atomic_add v229, v238, s[48:51], 0 offen sc1
    s_mov_b64 exec, -1
L_noclr:
    s_mov_b32 s39, 0x3db8aa3b
    v_bfe_u32 v236, v233, 2, 2
    v_bfe_u32 v237, v233, 4, 1
    v_and_b32 v238, 1, v233
    v_bfe_u32 v239, v233, 1, 1
    v_and_b32 v240, 15, v233
    s_lshl_b32 s6, s62, 8
    s_lshl_b32 s7, s62, 14
    v_xor_b32 v241, v234, v240
    v_lshlrev_b32 v241, 4, v241
    v_lshl_add_u32 v241, v235, 9, v241
    s_add_u32 s37, s6, s7
    v_add_u32 v208, s37, v241
    v_lshl_add_u32 v241, v237, 1, v239
    v_lshlrev_b32 v242, 2, v236
    v_xor_b32 v243, v241, v242
    v_lshlrev_b32 v243, 4, v243
    v_lshl_add_u32 v243, v238, 3, v243
    v_lshl_add_u32 v244, v234, 2, v236
    v_lshl_add_u32 v243, v244, 9, v243
    v_add_u32 v209, s37, v243
    v_lshrrev_b32 v243, 1, v236
    v_xor_b32 v243, s62, v243
    v_lshl_add_u32 v243, v243, 2, v241
    v_lshlrev_b32 v243, 4, v243
    v_lshl_add_u32 v243, v238, 3, v243
    v_lshl_add_u32 v243, v244, 7, v243
    v_add_u32 v211, s7, v243
    v_lshl_add_u32 v241, v237, 1, v238
    v_xor_b32 v243, v241, v242
    v_lshlrev_b32 v243, 4, v243
    v_lshl_add_u32 v243, v239, 3, v243
    v_lshl_add_u32 v244, v234, 3, v236
    v_lshl_add_u32 v243, v244, 9, v243
    v_add_u32 v212, s6, v243
    v_bfe_u32 v241, v235, 1, 3
    v_xor_b32 v241, v241, v234
    v_lshlrev_b32 v241, 4, v241
    v_lshl_add_u32 v241, v235, 7, v241
    s_lshl_b32 s6, s47, 12
    s_add_u32 s6, s6, 131072
    v_add_u32 v210, s6, v241
    s_lshl_b32 s6, s32, 13
    s_add_u32 s6, s6, 131072
    v_add_u32 v214, s6, v227
    v_xor_b32 v213, 0x2000, v214
    v_lshlrev_b32 v241, 3, v233
    v_add_u32 v216, s6, v241
    v_xor_b32 v215, 0x2000, v216
    s_lshl_b32 s6, s5, 4
    s_add_u32 s6, s6, s47
    s_lshl_b32 s6, s6, 8
    s_lshl_b32 s7, s62, 6
    s_add_u32 s6, s6, s7
    s_lshl_b32 s7, s3, 2
    s_add_u32 s6, s6, s7
    v_mov_b32 v228, s6
    v_mov_b32 v192, v212
    v_xor_b32 v193, 64, v192
    v_xor_b32 v194, 128, v192
    v_xor_b32 v195, 192, v192
    v_add_u32 v196, 0x10000, v192
    v_add_u32 v197, 0x10000, v193
    v_add_u32 v198, 0x10000, v194
    v_add_u32 v199, 0x10000, v195
    v_mov_b32 v200, v210
    v_xor_b32 v201, 32, v200
    v_xor_b32 v202, 64, v200
    v_xor_b32 v203, 96, v200
    s_barrier
    ds_read_b128 v[128:131], v200 offset:0
    ds_read_b64_tr_b16 v[160:161], v192 offset:0
    ds_read_b64_tr_b16 v[162:163], v192 offset:2048
    ds_read_b128 v[132:135], v201 offset:0
    ds_read_b64_tr_b16 v[164:165], v193 offset:0
    ds_read_b64_tr_b16 v[166:167], v193 offset:2048
    ds_read_b64_tr_b16 v[168:169], v194 offset:0
    ds_read_b64_tr_b16 v[170:171], v194 offset:2048
    ds_read_b64_tr_b16 v[172:173], v195 offset:0
    ds_read_b64_tr_b16 v[174:175], v195 offset:2048
    ds_read_b64_tr_b16 v[176:177], v192 offset:8192
    ds_read_b64_tr_b16 v[178:179], v192 offset:10240
    ds_read_b64_tr_b16 v[180:181], v193 offset:8192
    ds_read_b64_tr_b16 v[182:183], v193 offset:10240
    ds_read_b128 v[136:139], v202 offset:0
    ds_read_b128 v[140:143], v203 offset:0
    s_waitcnt lgkmcnt(13)
    v_mfma_f32_32x32x16_bf16 v[0:15], v[160:163], v[128:131], 0
    ds_read_b64_tr_b16 v[184:185], v194 offset:8192
    ds_read_b64_tr_b16 v[186:187], v194 offset:10240
    s_waitcnt lgkmcnt(12)
    v_mfma_f32_32x32x16_bf16 v[16:31], v[164:167], v[128:131], 0
    ds_read_b64_tr_b16 v[188:189], v195 offset:8192
    ds_read_b64_tr_b16 v[190:191], v195 offset:10240
    s_waitcnt lgkmcnt(12)
    v_mfma_f32_32x32x16_bf16 v[32:47], v[168:171], v[128:131], 0
    ds_read_b64_tr_b16 v[160:161], v192 offset:16384
    ds_read_b64_tr_b16 v[162:163], v192 offset:18432
    s_waitcnt lgkmcnt(12)
    v_mfma_f32_32x32x16_bf16 v[48:63], v[172:175], v[128:131], 0
    ds_read_b64_tr_b16 v[164:165], v193 offset:16384
    ds_read_b64_tr_b16 v[166:167], v193 offset:18432
    s_waitcnt lgkmcnt(12)
    v_mfma_f32_32x32x16_bf16 v[0:15], v[176:179], v[132:135], v[0:15]
    ds_read_b64_tr_b16 v[168:169], v194 offset:16384
    ds_read_b64_tr_b16 v[170:171], v194 offset:18432
    s_waitcnt lgkmcnt(12)
    v_mfma_f32_32x32x16_bf16 v[16:31], v[180:183], v[132:135], v[16:31]
    ds_read_b64_tr_b16 v[172:173], v195 offset:16384
    ds_read_b64_tr_b16 v[174:175], v195 offset:18432
    s_waitcnt lgkmcnt(10)
    v_mfma_f32_32x32x16_bf16 v[32:47], v[184:187], v[132:135], v[32:47]
    ds_read_b64_tr_b16 v[176:177], v192 offset:24576
    ds_read_b64_tr_b16 v[178:179], v192 offset:26624
    s_waitcnt lgkmcnt(10)
    v_mfma_f32_32x32x16_bf16 v[48:63], v[188:191], v[132:135], v[48:63]
    ds_read_b64_tr_b16 v[180:181], v193 offset:24576
    ds_read_b64_tr_b16 v[182:183], v193 offset:26624
    s_waitcnt lgkmcnt(10)
    v_mfma_f32_32x32x16_bf16 v[0:15], v[160:163], v[136:139], v[0:15]
    ds_read_b64_tr_b16 v[184:185], v194 offset:24576
    ds_read_b64_tr_b16 v[186:187], v194 offset:26624
    s_waitcnt lgkmcnt(10)
    v_mfma_f32_32x32x16_bf16 v[16:31], v[164:167], v[136:139], v[16:31]
    ds_read_b64_tr_b16 v[188:189], v195 offset:24576
    ds_read_b64_tr_b16 v[190:191], v195 offset:26624
    s_waitcnt lgkmcnt(10)
    v_mfma_f32_32x32x16_bf16 v[32:47], v[168:171], v[136:139], v[32:47]
    s_barrier
    ds_read_b128 v[128:131], v200 offset:8192
    ds_read_b64_tr_b16 v[160:161], v192 offset:32768
    ds_read_b64_tr_b16 v[162:163], v192 offset:34816
    s_waitcnt lgkmcnt(11)
    v_mfma_f32_32x32x16_bf16 v[48:63], v[172:175], v[136:139], v[48:63]
    ds_read_b64_tr_b16 v[164:165], v193 offset:32768
    ds_read_b64_tr_b16 v[166:167], v193 offset:34816
    ds_read_b128 v[132:135], v201 offset:8192
    ds_read_b128 v[136:139], v202 offset:8192
    s_waitcnt lgkmcnt(13)
    v_mfma_f32_32x32x16_bf16 v[0:15], v[176:179], v[140:143], v[0:15]
    ds_read_b64_tr_b16 v[168:169], v194 offset:32768
    ds_read_b64_tr_b16 v[170:171], v194 offset:34816
    s_waitcnt lgkmcnt(13)
    v_mfma_f32_32x32x16_bf16 v[16:31], v[180:183], v[140:143], v[16:31]
    ds_read_b64_tr_b16 v[172:173], v195 offset:32768
    ds_read_b64_tr_b16 v[174:175], v195 offset:34816
    s_waitcnt lgkmcnt(13)
    v_mfma_f32_32x32x16_bf16 v[32:47], v[184:187], v[140:143], v[32:47]
    ds_read_b64_tr_b16 v[176:177], v192 offset:40960
    ds_read_b64_tr_b16 v[178:179], v192 offset:43008
    s_waitcnt lgkmcnt(13)
    v_mfma_f32_32x32x16_bf16 v[48:63], v[188:191], v[140:143], v[48:63]
    ds_read_b64_tr_b16 v[180:181], v193 offset:40960
    ds_read_b64_tr_b16 v[182:183], v193 offset:43008
    ds_read_b128 v[140:143], v203 offset:8192
    s_waitcnt lgkmcnt(13)
    v_mfma_f32_32x32x16_bf16 v[0:15], v[160:163], v[128:131], v[0:15]
    ds_read_b64_tr_b16 v[184:185], v194 offset:40960
    ds_read_b64_tr_b16 v[186:187], v194 offset:43008
    s_waitcnt lgkmcnt(13)
    v_mfma_f32_32x32x16_bf16 v[16:31], v[164:167], v[128:131], v[16:31]
    ds_read_b64_tr_b16 v[188:189], v195 offset:40960
    ds_read_b64_tr_b16 v[190:191], v195 offset:43008
    s_waitcnt lgkmcnt(11)
    v_mfma_f32_32x32x16_bf16 v[32:47], v[168:171], v[128:131], v[32:47]
    ds_read_b64_tr_b16 v[160:161], v192 offset:49152
    ds_read_b64_tr_b16 v[162:163], v192 offset:51200
    s_waitcnt lgkmcnt(11)
    v_mfma_f32_32x32x16_bf16 v[48:63], v[172:175], v[128:131], v[48:63]
    ds_read_b64_tr_b16 v[164:165], v193 offset:49152
    ds_read_b64_tr_b16 v[166:167], v193 offset:51200
    s_waitcnt lgkmcnt(11)
    v_mfma_f32_32x32x16_bf16 v[0:15], v[176:179], v[132:135], v[0:15]
    ds_read_b64_tr_b16 v[168:169], v194 offset:49152
    ds_read_b64_tr_b16 v[170:171], v194 offset:51200
    s_waitcnt lgkmcnt(11)
    v_mfma_f32_32x32x16_bf16 v[16:31], v[180:183], v[132:135], v[16:31]
    ds_read_b64_tr_b16 v[172:173], v195 offset:49152
    ds_read_b64_tr_b16 v[174:175], v195 offset:51200
    s_waitcnt lgkmcnt(10)
    v_mfma_f32_32x32x16_bf16 v[32:47], v[184:187], v[132:135], v[32:47]
    ds_read_b64_tr_b16 v[176:177], v192 offset:57344
    ds_read_b64_tr_b16 v[178:179], v192 offset:59392
    s_waitcnt lgkmcnt(10)
    v_mfma_f32_32x32x16_bf16 v[48:63], v[188:191], v[132:135], v[48:63]
    ds_read_b64_tr_b16 v[180:181], v193 offset:57344
    ds_read_b64_tr_b16 v[182:183], v193 offset:59392
    s_waitcnt lgkmcnt(10)
    v_mfma_f32_32x32x16_bf16 v[0:15], v[160:163], v[136:139], v[0:15]
    ds_read_b64_tr_b16 v[184:185], v194 offset:57344
    ds_read_b64_tr_b16 v[186:187], v194 offset:59392
    s_waitcnt lgkmcnt(10)
    v_mfma_f32_32x32x16_bf16 v[16:31], v[164:167], v[136:139], v[16:31]
    ds_read_b64_tr_b16 v[188:189], v195 offset:57344
    ds_read_b64_tr_b16 v[190:191], v195 offset:59392
    s_waitcnt lgkmcnt(10)
    v_mfma_f32_32x32x16_bf16 v[32:47], v[168:171], v[136:139], v[32:47]
    s_barrier
    ds_read_b128 v[128:131], v200 offset:16384
    ds_read_b64_tr_b16 v[160:161], v196 offset:0
    ds_read_b64_tr_b16 v[162:163], v196 offset:2048
    s_waitcnt lgkmcnt(11)
    v_mfma_f32_32x32x16_bf16 v[48:63], v[172:175], v[136:139], v[48:63]
    ds_read_b64_tr_b16 v[164:165], v197 offset:0
    ds_read_b64_tr_b16 v[166:167], v197 offset:2048
    ds_read_b128 v[132:135], v201 offset:16384
    ds_read_b128 v[136:139], v202 offset:16384
    s_waitcnt lgkmcnt(13)
    v_mfma_f32_32x32x16_bf16 v[0:15], v[176:179], v[140:143], v[0:15]
    ds_read_b64_tr_b16 v[168:169], v198 offset:0
    ds_read_b64_tr_b16 v[170:171], v198 offset:2048
    s_waitcnt lgkmcnt(13)
    v_mfma_f32_32x32x16_bf16 v[16:31], v[180:183], v[140:143], v[16:31]
    ds_read_b64_tr_b16 v[172:173], v199 offset:0
    ds_read_b64_tr_b16 v[174:175], v199 offset:2048
    s_waitcnt lgkmcnt(13)
    v_mfma_f32_32x32x16_bf16 v[32:47], v[184:187], v[140:143], v[32:47]
    ds_read_b64_tr_b16 v[176:177], v196 offset:8192
    ds_read_b64_tr_b16 v[178:179], v196 offset:10240
    s_waitcnt lgkmcnt(13)
    v_mfma_f32_32x32x16_bf16 v[48:63], v[188:191], v[140:143], v[48:63]
    ds_read_b64_tr_b16 v[180:181], v197 offset:8192
    ds_read_b64_tr_b16 v[182:183], v197 offset:10240
    ds_read_b128 v[140:143], v203 offset:16384
    s_waitcnt lgkmcnt(13)
    v_mfma_f32_32x32x16_bf16 v[0:15], v[160:163], v[128:131], v[0:15]
    ds_read_b64_tr_b16 v[184:185], v198 offset:8192
    ds_read_b64_tr_b16 v[186:187], v198 offset:10240
    s_waitcnt lgkmcnt(13)
    v_mfma_f32_32x32x16_bf16 v[16:31], v[164:167], v[128:131], v[16:31]
    ds_read_b64_tr_b16 v[188:189], v199 offset:8192
    ds_read_b64_tr_b16 v[190:191], v199 offset:10240
    s_waitcnt lgkmcnt(11)
    v_mfma_f32_32x32x16_bf16 v[32:47], v[168:171], v[128:131], v[32:47]
    ds_read_b64_tr_b16 v[160:161], v196 offset:16384
    ds_read_b64_tr_b16 v[162:163], v196 offset:18432
    s_waitcnt lgkmcnt(11)
    v_mfma_f32_32x32x16_bf16 v[48:63], v[172:175], v[128:131], v[48:63]
    ds_read_b64_tr_b16 v[164:165], v197 offset:16384
    ds_read_b64_tr_b16 v[166:167], v197 offset:18432
    s_waitcnt lgkmcnt(11)
    v_mfma_f32_32x32x16_bf16 v[0:15], v[176:179], v[132:135], v[0:15]
    ds_read_b64_tr_b16 v[168:169], v198 offset:16384
    ds_read_b64_tr_b16 v[170:171], v198 offset:18432
    s_waitcnt lgkmcnt(11)
    v_mfma_f32_32x32x16_bf16 v[16:31], v[180:183], v[132:135], v[16:31]
    ds_read_b64_tr_b16 v[172:173], v199 offset:16384
    ds_read_b64_tr_b16 v[174:175], v199 offset:18432
    s_waitcnt lgkmcnt(10)
    v_mfma_f32_32x32x16_bf16 v[32:47], v[184:187], v[132:135], v[32:47]
    ds_read_b64_tr_b16 v[176:177], v196 offset:24576
    ds_read_b64_tr_b16 v[178:179], v196 offset:26624
    s_waitcnt lgkmcnt(10)
    v_mfma_f32_32x32x16_bf16 v[48:63], v[188:191], v[132:135], v[48:63]
    ds_read_b64_tr_b16 v[180:181], v197 offset:24576
    ds_read_b64_tr_b16 v[182:183], v197 offset:26624
    s_waitcnt lgkmcnt(10)
    v_mfma_f32_32x32x16_bf16 v[0:15], v[160:163], v[136:139], v[0:15]
    ds_read_b64_tr_b16 v[184:185], v198 offset:24576
    ds_read_b64_tr_b16 v[186:187], v198 offset:26624
    s_waitcnt lgkmcnt(10)
    v_mfma_f32_32x32x16_bf16 v[16:31], v[164:167], v[136:139], v[16:31]
    ds_read_b64_tr_b16 v[188:189], v199 offset:24576
    ds_read_b64_tr_b16 v[190:191], v199 offset:26624
    s_waitcnt lgkmcnt(10)
    v_mfma_f32_32x32x16_bf16 v[32:47], v[168:171], v[136:139], v[32:47]
    s_barrier
    ds_read_b128 v[128:131], v200 offset:24576
    ds_read_b64_tr_b16 v[160:161], v196 offset:32768
    ds_read_b64_tr_b16 v[162:163], v196 offset:34816
    s_waitcnt lgkmcnt(11)
    v_mfma_f32_32x32x16_bf16 v[48:63], v[172:175], v[136:139], v[48:63]
    ds_read_b64_tr_b16 v[164:165], v197 offset:32768
    ds_read_b64_tr_b16 v[166:167], v197 offset:34816
    ds_read_b128 v[132:135], v201 offset:24576
    ds_read_b128 v[136:139], v202 offset:24576
    s_waitcnt lgkmcnt(13)
    v_mfma_f32_32x32x16_bf16 v[0:15], v[176:179], v[140:143], v[0:15]
    ds_read_b64_tr_b16 v[168:169], v198 offset:32768
    ds_read_b64_tr_b16 v[170:171], v198 offset:34816
    s_waitcnt lgkmcnt(13)
    v_mfma_f32_32x32x16_bf16 v[16:31], v[180:183], v[140:143], v[16:31]
    ds_read_b64_tr_b16 v[172:173], v199 offset:32768
    ds_read_b64_tr_b16 v[174:175], v199 offset:34816
    s_waitcnt lgkmcnt(13)
    v_mfma_f32_32x32x16_bf16 v[32:47], v[184:187], v[140:143], v[32:47]
    ds_read_b64_tr_b16 v[176:177], v196 offset:40960
    ds_read_b64_tr_b16 v[178:179], v196 offset:43008
    s_waitcnt lgkmcnt(13)
    v_mfma_f32_32x32x16_bf16 v[48:63], v[188:191], v[140:143], v[48:63]
    ds_read_b64_tr_b16 v[180:181], v197 offset:40960
    ds_read_b64_tr_b16 v[182:183], v197 offset:43008
    ds_read_b128 v[140:143], v203 offset:24576
    s_waitcnt lgkmcnt(13)
    v_mfma_f32_32x32x16_bf16 v[0:15], v[160:163], v[128:131], v[0:15]
    ds_read_b64_tr_b16 v[184:185], v198 offset:40960
    ds_read_b64_tr_b16 v[186:187], v198 offset:43008
    s_waitcnt lgkmcnt(13)
    v_mfma_f32_32x32x16_bf16 v[16:31], v[164:167], v[128:131], v[16:31]
    ds_read_b64_tr_b16 v[188:189], v199 offset:40960
    ds_read_b64_tr_b16 v[190:191], v199 offset:43008
    s_waitcnt lgkmcnt(11)
    v_mfma_f32_32x32x16_bf16 v[32:47], v[168:171], v[128:131], v[32:47]
    ds_read_b64_tr_b16 v[160:161], v196 offset:49152
    ds_read_b64_tr_b16 v[162:163], v196 offset:51200
    s_waitcnt lgkmcnt(11)
    v_mfma_f32_32x32x16_bf16 v[48:63], v[172:175], v[128:131], v[48:63]
    ds_read_b64_tr_b16 v[164:165], v197 offset:49152
    ds_read_b64_tr_b16 v[166:167], v197 offset:51200
    s_waitcnt lgkmcnt(11)
    v_mfma_f32_32x32x16_bf16 v[0:15], v[176:179], v[132:135], v[0:15]
    ds_read_b64_tr_b16 v[168:169], v198 offset:49152
    ds_read_b64_tr_b16 v[170:171], v198 offset:51200
    s_waitcnt lgkmcnt(11)
    v_mfma_f32_32x32x16_bf16 v[16:31], v[180:183], v[132:135], v[16:31]
    ds_read_b64_tr_b16 v[172:173], v199 offset:49152
    ds_read_b64_tr_b16 v[174:175], v199 offset:51200
    s_waitcnt lgkmcnt(10)
    v_mfma_f32_32x32x16_bf16 v[32:47], v[184:187], v[132:135], v[32:47]
    ds_read_b64_tr_b16 v[176:177], v196 offset:57344
    ds_read_b64_tr_b16 v[178:179], v196 offset:59392
    s_waitcnt lgkmcnt(10)
    v_mfma_f32_32x32x16_bf16 v[48:63], v[188:191], v[132:135], v[48:63]
    ds_read_b64_tr_b16 v[180:181], v197 offset:57344
    ds_read_b64_tr_b16 v[182:183], v197 offset:59392
    s_waitcnt lgkmcnt(10)
    v_mfma_f32_32x32x16_bf16 v[0:15], v[160:163], v[136:139], v[0:15]
    ds_read_b64_tr_b16 v[184:185], v198 offset:57344
    ds_read_b64_tr_b16 v[186:187], v198 offset:59392
    s_waitcnt lgkmcnt(10)
    v_mfma_f32_32x32x16_bf16 v[16:31], v[164:167], v[136:139], v[16:31]
    ds_read_b64_tr_b16 v[188:189], v199 offset:57344
    ds_read_b64_tr_b16 v[190:191], v199 offset:59392
    s_waitcnt lgkmcnt(10)
    v_mfma_f32_32x32x16_bf16 v[32:47], v[168:171], v[136:139], v[32:47]
    s_barrier
    ds_read_b128 v[128:131], v200 offset:0
    ds_read_b64_tr_b16 v[160:161], v192 offset:0
    ds_read_b64_tr_b16 v[162:163], v192 offset:2048
    s_waitcnt lgkmcnt(11)
    v_mfma_f32_32x32x16_bf16 v[48:63], v[172:175], v[136:139], v[48:63]
    ds_read_b64_tr_b16 v[164:165], v193 offset:0
    ds_read_b64_tr_b16 v[166:167], v193 offset:2048
    ds_read_b128 v[132:135], v201 offset:0
    ds_read_b128 v[136:139], v202 offset:0
    s_waitcnt lgkmcnt(13)
    v_mfma_f32_32x32x16_bf16 v[0:15], v[176:179], v[140:143], v[0:15]
    ds_read_b64_tr_b16 v[168:169], v194 offset:0
    ds_read_b64_tr_b16 v[170:171], v194 offset:2048
    s_waitcnt lgkmcnt(13)
    v_mfma_f32_32x32x16_bf16 v[16:31], v[180:183], v[140:143], v[16:31]
    ds_read_b64_tr_b16 v[172:173], v195 offset:0
    ds_read_b64_tr_b16 v[174:175], v195 offset:2048
    s_waitcnt lgkmcnt(13)
    v_mfma_f32_32x32x16_bf16 v[32:47], v[184:187], v[140:143], v[32:47]
    ds_read_b64_tr_b16 v[176:177], v192 offset:8192
    ds_read_b64_tr_b16 v[178:179], v192 offset:10240
    s_waitcnt lgkmcnt(13)
    v_mfma_f32_32x32x16_bf16 v[48:63], v[188:191], v[140:143], v[48:63]
    ds_read_b64_tr_b16 v[180:181], v193 offset:8192
    ds_read_b64_tr_b16 v[182:183], v193 offset:10240
    ds_read_b128 v[140:143], v203 offset:0
    s_waitcnt lgkmcnt(13)
    v_mfma_f32_32x32x16_bf16 v[0:15], v[160:163], v[128:131], v[0:15]
    ds_read_b64_tr_b16 v[184:185], v194 offset:8192
    ds_read_b64_tr_b16 v[186:187], v194 offset:10240
    s_waitcnt lgkmcnt(13)
    v_mfma_f32_32x32x16_bf16 v[16:31], v[164:167], v[128:131], v[16:31]
    ds_read_b64_tr_b16 v[188:189], v195 offset:8192
    ds_read_b64_tr_b16 v[190:191], v195 offset:10240
    s_waitcnt lgkmcnt(11)
    v_mfma_f32_32x32x16_bf16 v[32:47], v[168:171], v[128:131], v[32:47]
    ds_read_b64_tr_b16 v[160:161], v192 offset:16384
    ds_read_b64_tr_b16 v[162:163], v192 offset:18432
    s_waitcnt lgkmcnt(11)
    v_mfma_f32_32x32x16_bf16 v[48:63], v[172:175], v[128:131], v[48:63]
    ds_read_b64_tr_b16 v[164:165], v193 offset:16384
    ds_read_b64_tr_b16 v[166:167], v193 offset:18432
    s_waitcnt lgkmcnt(11)
    v_mfma_f32_32x32x16_bf16 v[0:15], v[176:179], v[132:135], v[0:15]
    ds_read_b64_tr_b16 v[168:169], v194 offset:16384
    ds_read_b64_tr_b16 v[170:171], v194 offset:18432
    s_waitcnt lgkmcnt(11)
    v_mfma_f32_32x32x16_bf16 v[16:31], v[180:183], v[132:135], v[16:31]
    ds_read_b64_tr_b16 v[172:173], v195 offset:16384
    ds_read_b64_tr_b16 v[174:175], v195 offset:18432
    s_waitcnt lgkmcnt(10)
    v_mfma_f32_32x32x16_bf16 v[32:47], v[184:187], v[132:135], v[32:47]
    ds_read_b64_tr_b16 v[176:177], v192 offset:24576
    ds_read_b64_tr_b16 v[178:179], v192 offset:26624
    s_waitcnt lgkmcnt(10)
    v_mfma_f32_32x32x16_bf16 v[48:63], v[188:191], v[132:135], v[48:63]
    ds_read_b64_tr_b16 v[180:181], v193 offset:24576
    ds_read_b64_tr_b16 v[182:183], v193 offset:26624
    s_waitcnt lgkmcnt(10)
    v_mfma_f32_32x32x16_bf16 v[0:15], v[160:163], v[136:139], v[0:15]
    ds_read_b64_tr_b16 v[184:185], v194 offset:24576
    ds_read_b64_tr_b16 v[186:187], v194 offset:26624
    s_waitcnt lgkmcnt(10)
    v_mfma_f32_32x32x16_bf16 v[16:31], v[164:167], v[136:139], v[16:31]
    ds_read_b64_tr_b16 v[188:189], v195 offset:24576
    ds_read_b64_tr_b16 v[190:191], v195 offset:26624
    s_waitcnt lgkmcnt(10)
    v_mfma_f32_32x32x16_bf16 v[32:47], v[168:171], v[136:139], v[32:47]
    s_barrier
    ds_read_b128 v[128:131], v200 offset:8192
    ds_read_b64_tr_b16 v[160:161], v192 offset:32768
    ds_read_b64_tr_b16 v[162:163], v192 offset:34816
    s_waitcnt lgkmcnt(11)
    v_mfma_f32_32x32x16_bf16 v[48:63], v[172:175], v[136:139], v[48:63]
    ds_read_b64_tr_b16 v[164:165], v193 offset:32768
    ds_read_b64_tr_b16 v[166:167], v193 offset:34816
    ds_read_b128 v[132:135], v201 offset:8192
    ds_read_b128 v[136:139], v202 offset:8192
    s_waitcnt lgkmcnt(13)
    v_mfma_f32_32x32x16_bf16 v[0:15], v[176:179], v[140:143], v[0:15]
    ds_read_b64_tr_b16 v[168:169], v194 offset:32768
    ds_read_b64_tr_b16 v[170:171], v194 offset:34816
    s_waitcnt lgkmcnt(13)
    v_mfma_f32_32x32x16_bf16 v[16:31], v[180:183], v[140:143], v[16:31]
    ds_read_b64_tr_b16 v[172:173], v195 offset:32768
    ds_read_b64_tr_b16 v[174:175], v195 offset:34816
    s_waitcnt lgkmcnt(13)
    v_mfma_f32_32x32x16_bf16 v[32:47], v[184:187], v[140:143], v[32:47]
    ds_read_b64_tr_b16 v[176:177], v192 offset:40960
    ds_read_b64_tr_b16 v[178:179], v192 offset:43008
    s_waitcnt lgkmcnt(13)
    v_mfma_f32_32x32x16_bf16 v[48:63], v[188:191], v[140:143], v[48:63]
    ds_read_b64_tr_b16 v[180:181], v193 offset:40960
    ds_read_b64_tr_b16 v[182:183], v193 offset:43008
    ds_read_b128 v[140:143], v203 offset:8192
    s_waitcnt lgkmcnt(13)
    v_mfma_f32_32x32x16_bf16 v[0:15], v[160:163], v[128:131], v[0:15]
    ds_read_b64_tr_b16 v[184:185], v194 offset:40960
    ds_read_b64_tr_b16 v[186:187], v194 offset:43008
    s_waitcnt lgkmcnt(13)
    v_mfma_f32_32x32x16_bf16 v[16:31], v[164:167], v[128:131], v[16:31]
    ds_read_b64_tr_b16 v[188:189], v195 offset:40960
    ds_read_b64_tr_b16 v[190:191], v195 offset:43008
    s_waitcnt lgkmcnt(11)
    v_mfma_f32_32x32x16_bf16 v[32:47], v[168:171], v[128:131], v[32:47]
    ds_read_b64_tr_b16 v[160:161], v192 offset:49152
    ds_read_b64_tr_b16 v[162:163], v192 offset:51200
    s_waitcnt lgkmcnt(11)
    v_mfma_f32_32x32x16_bf16 v[48:63], v[172:175], v[128:131], v[48:63]
    ds_read_b64_tr_b16 v[164:165], v193 offset:49152
    ds_read_b64_tr_b16 v[166:167], v193 offset:51200
    s_waitcnt lgkmcnt(11)
    v_mfma_f32_32x32x16_bf16 v[0:15], v[176:179], v[132:135], v[0:15]
    ds_read_b64_tr_b16 v[168:169], v194 offset:49152
    ds_read_b64_tr_b16 v[170:171], v194 offset:51200
    s_waitcnt lgkmcnt(11)
    v_mfma_f32_32x32x16_bf16 v[16:31], v[180:183], v[132:135], v[16:31]
    ds_read_b64_tr_b16 v[172:173], v195 offset:49152
    ds_read_b64_tr_b16 v[174:175], v195 offset:51200
    s_waitcnt lgkmcnt(10)
    v_mfma_f32_32x32x16_bf16 v[32:47], v[184:187], v[132:135], v[32:47]
    ds_read_b64_tr_b16 v[176:177], v192 offset:57344
    ds_read_b64_tr_b16 v[178:179], v192 offset:59392
    s_waitcnt lgkmcnt(10)
    v_mfma_f32_32x32x16_bf16 v[48:63], v[188:191], v[132:135], v[48:63]
    ds_read_b64_tr_b16 v[180:181], v193 offset:57344
    ds_read_b64_tr_b16 v[182:183], v193 offset:59392
    s_waitcnt lgkmcnt(10)
    v_mfma_f32_32x32x16_bf16 v[0:15], v[160:163], v[136:139], v[0:15]
    ds_read_b64_tr_b16 v[184:185], v194 offset:57344
    ds_read_b64_tr_b16 v[186:187], v194 offset:59392
    s_waitcnt lgkmcnt(10)
    v_mfma_f32_32x32x16_bf16 v[16:31], v[164:167], v[136:139], v[16:31]
    ds_read_b64_tr_b16 v[188:189], v195 offset:57344
    ds_read_b64_tr_b16 v[190:191], v195 offset:59392
    s_waitcnt lgkmcnt(10)
    v_mfma_f32_32x32x16_bf16 v[32:47], v[168:171], v[136:139], v[32:47]
    s_barrier
    ds_read_b128 v[128:131], v200 offset:16384
    ds_read_b64_tr_b16 v[160:161], v196 offset:0
    ds_read_b64_tr_b16 v[162:163], v196 offset:2048
    s_waitcnt lgkmcnt(11)
    v_mfma_f32_32x32x16_bf16 v[48:63], v[172:175], v[136:139], v[48:63]
    ds_read_b64_tr_b16 v[164:165], v197 offset:0
    ds_read_b64_tr_b16 v[166:167], v197 offset:2048
    ds_read_b128 v[132:135], v201 offset:16384
    ds_read_b128 v[136:139], v202 offset:16384
    s_waitcnt lgkmcnt(13)
    v_mfma_f32_32x32x16_bf16 v[0:15], v[176:179], v[140:143], v[0:15]
    ds_read_b64_tr_b16 v[168:169], v198 offset:0
    ds_read_b64_tr_b16 v[170:171], v198 offset:2048
    s_waitcnt lgkmcnt(13)
    v_mfma_f32_32x32x16_bf16 v[16:31], v[180:183], v[140:143], v[16:31]
    ds_read_b64_tr_b16 v[172:173], v199 offset:0
    ds_read_b64_tr_b16 v[174:175], v199 offset:2048
    s_waitcnt lgkmcnt(13)
    v_mfma_f32_32x32x16_bf16 v[32:47], v[184:187], v[140:143], v[32:47]
    ds_read_b64_tr_b16 v[176:177], v196 offset:8192
    ds_read_b64_tr_b16 v[178:179], v196 offset:10240
    s_waitcnt lgkmcnt(13)
    v_mfma_f32_32x32x16_bf16 v[48:63], v[188:191], v[140:143], v[48:63]
    ds_read_b64_tr_b16 v[180:181], v197 offset:8192
    ds_read_b64_tr_b16 v[182:183], v197 offset:10240
    ds_read_b128 v[140:143], v203 offset:16384
    s_waitcnt lgkmcnt(13)
    v_mfma_f32_32x32x16_bf16 v[0:15], v[160:163], v[128:131], v[0:15]
    ds_read_b64_tr_b16 v[184:185], v198 offset:8192
    ds_read_b64_tr_b16 v[186:187], v198 offset:10240
    s_waitcnt lgkmcnt(13)
    v_mfma_f32_32x32x16_bf16 v[16:31], v[164:167], v[128:131], v[16:31]
    ds_read_b64_tr_b16 v[188:189], v199 offset:8192
    ds_read_b64_tr_b16 v[190:191], v199 offset:10240
    s_waitcnt lgkmcnt(11)
    v_mfma_f32_32x32x16_bf16 v[32:47], v[168:171], v[128:131], v[32:47]
    ds_read_b64_tr_b16 v[160:161], v196 offset:16384
    ds_read_b64_tr_b16 v[162:163], v196 offset:18432
    s_waitcnt lgkmcnt(11)
    v_mfma_f32_32x32x16_bf16 v[48:63], v[172:175], v[128:131], v[48:63]
    ds_read_b64_tr_b16 v[164:165], v197 offset:16384
    ds_read_b64_tr_b16 v[166:167], v197 offset:18432
    s_waitcnt lgkmcnt(11)
    v_mfma_f32_32x32x16_bf16 v[0:15], v[176:179], v[132:135], v[0:15]
    ds_read_b64_tr_b16 v[168:169], v198 offset:16384
    ds_read_b64_tr_b16 v[170:171], v198 offset:18432
    s_waitcnt lgkmcnt(11)
    v_mfma_f32_32x32x16_bf16 v[16:31], v[180:183], v[132:135], v[16:31]
    ds_read_b64_tr_b16 v[172:173], v199 offset:16384
    ds_read_b64_tr_b16 v[174:175], v199 offset:18432
    s_waitcnt lgkmcnt(10)
    v_mfma_f32_32x32x16_bf16 v[32:47], v[184:187], v[132:135], v[32:47]
    ds_read_b64_tr_b16 v[176:177], v196 offset:24576
    ds_read_b64_tr_b16 v[178:179], v196 offset:26624
    s_waitcnt lgkmcnt(10)
    v_mfma_f32_32x32x16_bf16 v[48:63], v[188:191], v[132:135], v[48:63]
    ds_read_b64_tr_b16 v[180:181], v197 offset:24576
    ds_read_b64_tr_b16 v[182:183], v197 offset:26624
    s_waitcnt lgkmcnt(10)
    v_mfma_f32_32x32x16_bf16 v[0:15], v[160:163], v[136:139], v[0:15]
    ds_read_b64_tr_b16 v[184:185], v198 offset:24576
    ds_read_b64_tr_b16 v[186:187], v198 offset:26624
    s_waitcnt lgkmcnt(10)
    v_mfma_f32_32x32x16_bf16 v[16:31], v[164:167], v[136:139], v[16:31]
    ds_read_b64_tr_b16 v[188:189], v199 offset:24576
    ds_read_b64_tr_b16 v[190:191], v199 offset:26624
    s_waitcnt lgkmcnt(10)
    v_mfma_f32_32x32x16_bf16 v[32:47], v[168:171], v[136:139], v[32:47]
    s_waitcnt lgkmcnt(8)
    v_mfma_f32_32x32x16_bf16 v[48:63], v[172:175], v[136:139], v[48:63]
    s_waitcnt lgkmcnt(6)
    v_mfma_f32_32x32x16_bf16 v[0:15], v[176:179], v[140:143], v[0:15]
    s_waitcnt lgkmcnt(4)
    v_mfma_f32_32x32x16_bf16 v[16:31], v[180:183], v[140:143], v[16:31]
    s_barrier
    s_waitcnt lgkmcnt(2)
    v_mfma_f32_32x32x16_bf16 v[32:47], v[184:187], v[140:143], v[32:47]
    s_waitcnt lgkmcnt(0)
    v_mfma_f32_32x32x16_bf16 v[48:63], v[188:191], v[140:143], v[48:63]
    s_nop 4
    v_cvt_pk_bf16_f32 v64, v0, v1
    v_cvt_pk_bf16_f32 v65, v2, v3
    v_cvt_pk_bf16_f32 v66, v4, v5
    v_cvt_pk_bf16_f32 v67, v6, v7
    v_cvt_pk_bf16_f32 v68, v8, v9
    v_cvt_pk_bf16_f32 v69, v10, v11
    v_cvt_pk_bf16_f32 v70, v12, v13
    v_cvt_pk_bf16_f32 v71, v14, v15
    v_cvt_pk_bf16_f32 v72, v16, v17
    v_cvt_pk_bf16_f32 v73, v18, v19
    v_cvt_pk_bf16_f32 v74, v20, v21
    v_cvt_pk_bf16_f32 v75, v22, v23
    v_cvt_pk_bf16_f32 v76, v24, v25
    v_cvt_pk_bf16_f32 v77, v26, v27
    v_cvt_pk_bf16_f32 v78, v28, v29
    v_cvt_pk_bf16_f32 v79, v30, v31
    v_cvt_pk_bf16_f32 v80, v32, v33
    v_cvt_pk_bf16_f32 v81, v34, v35
    v_cvt_pk_bf16_f32 v82, v36, v37
    v_cvt_pk_bf16_f32 v83, v38, v39
    v_cvt_pk_bf16_f32 v84, v40, v41
    v_cvt_pk_bf16_f32 v85, v42, v43
    v_cvt_pk_bf16_f32 v86, v44, v45
    v_cvt_pk_bf16_f32 v87, v46, v47
    v_cvt_pk_bf16_f32 v88, v48, v49
    v_cvt_pk_bf16_f32 v89, v50, v51
    v_cvt_pk_bf16_f32 v90, v52, v53
    v_cvt_pk_bf16_f32 v91, v54, v55
    v_cvt_pk_bf16_f32 v92, v56, v57
    v_cvt_pk_bf16_f32 v93, v58, v59
    v_cvt_pk_bf16_f32 v94, v60, v61
    v_cvt_pk_bf16_f32 v95, v62, v63
    ds_write_b128 v214, v[64:67] offset:0
    ds_write_b128 v214, v[68:71] offset:1024
    ds_write_b128 v214, v[72:75] offset:2048
    ds_write_b128 v214, v[76:79] offset:3072
    ds_write_b128 v214, v[80:83] offset:4096
    ds_write_b128 v214, v[84:87] offset:5120
    ds_write_b128 v214, v[88:91] offset:6144
    ds_write_b128 v214, v[92:95] offset:7168
    v_mov_b32 v0, 0
    v_mov_b32 v1, 0
    v_mov_b32 v2, 0
    v_mov_b32 v3, 0
    v_mov_b32 v4, 0
    v_mov_b32 v5, 0
    v_mov_b32 v6, 0
    v_mov_b32 v7, 0
    v_mov_b32 v8, 0
    v_mov_b32 v9, 0
    v_mov_b32 v10, 0
    v_mov_b32 v11, 0
    v_mov_b32 v12, 0
    v_mov_b32 v13, 0
    v_mov_b32 v14, 0
    v_mov_b32 v15, 0
    v_mov_b32 v16, 0
    v_mov_b32 v17, 0
    v_mov_b32 v18, 0
    v_mov_b32 v19, 0
    v_mov_b32 v20, 0
    v_mov_b32 v21, 0
    v_mov_b32 v22, 0
    v_mov_b32 v23, 0
    v_mov_b32 v24, 0
    v_mov_b32 v25, 0
    v_mov_b32 v26, 0
    v_mov_b32 v27, 0
    v_mov_b32 v28, 0
    v_mov_b32 v29, 0
    v_mov_b32 v30, 0
    v_mov_b32 v31, 0
    v_mov_b32 v32, 0
    v_mov_b32 v33, 0
    v_mov_b32 v34, 0
    v_mov_b32 v35, 0
    v_mov_b32 v36, 0
    v_mov_b32 v37, 0
    v_mov_b32 v38, 0
    v_mov_b32 v39, 0
    v_mov_b32 v40, 0
    v_mov_b32 v41, 0
    v_mov_b32 v42, 0
    v_mov_b32 v43, 0
    v_mov_b32 v44, 0
    v_mov_b32 v45, 0
    v_mov_b32 v46, 0
    v_mov_b32 v47, 0
    v_mov_b32 v48, 0
    v_mov_b32 v49, 0
    v_mov_b32 v50, 0
    v_mov_b32 v51, 0
    v_mov_b32 v52, 0
    v_mov_b32 v53, 0
    v_mov_b32 v54, 0
    v_mov_b32 v55, 0
    v_mov_b32 v56, 0
    v_mov_b32 v57, 0
    v_mov_b32 v58, 0
    v_mov_b32 v59, 0
    v_mov_b32 v60, 0
    v_mov_b32 v61, 0
    v_mov_b32 v62, 0
    v_mov_b32 v63, 0
    v_mov_b32 v225, 0xff61b1e6
    v_mov_b32 v223, 0xff61b1e6
    v_mov_b32 v218, 0xff61b1e6
    v_mov_b32 v222, 0
    v_mov_b32 v224, 0
    s_mov_b32 s35, 16
    s_mov_b32 s33, 98304
    v_add_u32 v192, s33, v208
    v_xor_b32 v193, 32, v192
    v_xor_b32 v194, 64, v192
    v_xor_b32 v195, 96, v192
    v_xor_b32 v196, 128, v192
    v_xor_b32 v197, 160, v192
    v_xor_b32 v198, 192, v192
    v_xor_b32 v199, 224, v192
    v_xor_b32 v200, 256, v192
    v_xor_b32 v201, 288, v192
    v_xor_b32 v202, 320, v192
    v_xor_b32 v203, 352, v192
    v_xor_b32 v204, 384, v192
    v_xor_b32 v205, 416, v192
    v_xor_b32 v206, 448, v192
    v_xor_b32 v207, 480, v192
    s_waitcnt lgkmcnt(0)
    s_barrier
    ds_read_b128 v[96:99], v213 offset:0
    ds_read_b128 v[100:103], v213 offset:1024
    ds_read_b128 v[104:107], v213 offset:2048
    ds_read_b128 v[108:111], v213 offset:3072
    ds_read_b128 v[112:115], v213 offset:4096
    ds_read_b128 v[116:119], v213 offset:5120
    ds_read_b128 v[120:123], v213 offset:6144
    ds_read_b128 v[124:127], v213 offset:7168
    s_branch L_loop1
L_loop:
    v_add_u32 v192, s33, v208
    v_xor_b32 v193, 32, v192
    v_xor_b32 v194, 64, v192
    v_xor_b32 v195, 96, v192
    v_xor_b32 v196, 128, v192
    v_xor_b32 v197, 160, v192
    v_xor_b32 v198, 192, v192
    v_xor_b32 v199, 224, v192
    v_xor_b32 v200, 256, v192
    v_xor_b32 v201, 288, v192
    v_xor_b32 v202, 320, v192
    v_xor_b32 v203, 352, v192
    v_xor_b32 v204, 384, v192
    v_xor_b32 v205, 416, v192
    v_xor_b32 v206, 448, v192
    v_xor_b32 v207, 480, v192
    s_barrier
L_loop1:
    ds_read_b128 v[160:163], v192
    ds_read_b128 v[164:167], v193
    ds_read_b128 v[168:171], v194
    ds_read_b128 v[172:175], v195
    ds_read_b128 v[176:179], v196
    ds_read_b128 v[180:183], v197
    ds_read_b128 v[184:187], v198
    s_add_u32 s6, s32, 6
    s_cmp_lg_u32 s35, s6
    s_cbranch_scc1 L_noprobe
    s_lshl_b32 s7, s5, 4
    v_mov_b32 v238, s7
    buffer_load_dword v239, v238, s[48:51], 0 offen sc1
L_noprobe:
    s_waitcnt lgkmcnt(6)
    v_mfma_f32_32x32x16_bf16 v[128:143], v[160:163], v[64:67], 0
    ds_read_b128 v[188:191], v199
    s_waitcnt lgkmcnt(6)
    v_mfma_f32_32x32x16_bf16 v[128:143], v[164:167], v[68:71], v[128:143]
    ds_read_b128 v[160:163], v200
    s_waitcnt lgkmcnt(6)
    v_mfma_f32_32x32x16_bf16 v[128:143], v[168:171], v[72:75], v[128:143]
    ds_read_b128 v[164:167], v201
    s_waitcnt lgkmcnt(6)
    v_mfma_f32_32x32x16_bf16 v[128:143], v[172:175], v[76:79], v[128:143]
    ds_read_b128 v[168:171], v202
    s_waitcnt lgkmcnt(6)
    v_mfma_f32_32x32x16_bf16 v[128:143], v[176:179], v[80:83], v[128:143]
    ds_read_b128 v[172:175], v203
    s_waitcnt lgkmcnt(6)
    v_mfma_f32_32x32x16_bf16 v[128:143], v[180:183], v[84:87], v[128:143]
    ds_read_b128 v[176:179], v204
    s_waitcnt lgkmcnt(6)
    v_mfma_f32_32x32x16_bf16 v[128:143], v[184:187], v[88:91], v[128:143]
    ds_read_b128 v[180:183], v205
    s_waitcnt lgkmcnt(6)
    v_mfma_f32_32x32x16_bf16 v[128:143], v[188:191], v[92:95], v[128:143]
    ds_read_b128 v[184:187], v206
    s_waitcnt lgkmcnt(6)
    v_mfma_f32_32x32x16_bf16 v[128:143], v[160:163], v[96:99], v[128:143]
    ds_read_b128 v[188:191], v207
    s_waitcnt lgkmcnt(6)
    v_mfma_f32_32x32x16_bf16 v[128:143], v[164:167], v[100:103], v[128:143]
    s_waitcnt lgkmcnt(5)
    v_mfma_f32_32x32x16_bf16 v[128:143], v[168:171], v[104:107], v[128:143]
    s_waitcnt lgkmcnt(4)
    v_mfma_f32_32x32x16_bf16 v[128:143], v[172:175], v[108:111], v[128:143]
    s_waitcnt lgkmcnt(3)
    v_mfma_f32_32x32x16_bf16 v[128:143], v[176:179], v[112:115], v[128:143]
    s_waitcnt lgkmcnt(2)
    v_mfma_f32_32x32x16_bf16 v[128:143], v[180:183], v[116:119], v[128:143]
    s_waitcnt lgkmcnt(1)
    v_mfma_f32_32x32x16_bf16 v[128:143], v[184:187], v[120:123], v[128:143]
    s_waitcnt lgkmcnt(0)
    v_mfma_f32_32x32x16_bf16 v[128:143], v[188:191], v[124:127], v[128:143]
    s_add_u32 s33, s33, 32768
    s_and_b32 s33, s33, 0x1ffff
    v_add_u32 v192, s33, v209
    v_xor_b32 v193, 64, v192
    v_xor_b32 v194, 128, v192
    v_xor_b32 v195, 192, v192
    v_xor_b32 v196, 16384, v192
    v_xor_b32 v197, 16448, v192
    v_xor_b32 v198, 16512, v192
    v_xor_b32 v199, 16576, v192
    s_nop 1
    v_max3_f32 v232, v128, v129, v130
    v_max3_f32 v232, v232, v131, v132
    v_max3_f32 v232, v232, v133, v134
    v_max3_f32 v232, v232, v135, v136
    v_max3_f32 v232, v232, v137, v138
    v_max3_f32 v232, v232, v139, v140
    v_max3_f32 v232, v232, v141, v142
    v_max_f32 v232, v232, v143
    v_cmp_gt_f32 vcc, v232, v223
    s_cbranch_vccnz L_rescA
L_rescAret:
    v_fma_f32 v128, v128, s39, -v222
    v_fma_f32 v129, v129, s39, -v222
    v_fma_f32 v130, v130, s39, -v222
    v_fma_f32 v131, v131, s39, -v222
    v_fma_f32 v132, v132, s39, -v222
    v_fma_f32 v133, v133, s39, -v222
    v_fma_f32 v134, v134, s39, -v222
    v_fma_f32 v135, v135, s39, -v222
    v_fma_f32 v136, v136, s39, -v222
    v_fma_f32 v137, v137, s39, -v222
    v_fma_f32 v138, v138, s39, -v222
    v_fma_f32 v139, v139, s39, -v222
    v_fma_f32 v140, v140, s39, -v222
    v_fma_f32 v141, v141, s39, -v222
    v_fma_f32 v142, v142, s39, -v222
    v_fma_f32 v143, v143, s39, -v222
    v_exp_f32 v128, v128
    v_exp_f32 v129, v129
    v_exp_f32 v130, v130
    v_exp_f32 v131, v131
    v_exp_f32 v132, v132
    v_exp_f32 v133, v133
    v_exp_f32 v134, v134
    v_exp_f32 v135, v135
    v_exp_f32 v136, v136
    v_exp_f32 v137, v137
    v_exp_f32 v138, v138
    v_exp_f32 v139, v139
    v_exp_f32 v140, v140
    v_exp_f32 v141, v141
    v_exp_f32 v142, v142
    v_exp_f32 v143, v143
    v_add_f32 v219, v128, v129
    v_add_f32 v226, v130, v131
    v_cvt_pk_bf16_f32 v144, v128, v129
    v_cvt_pk_bf16_f32 v145, v130, v131
    v_cvt_pk_bf16_f32 v146, v132, v133
    v_cvt_pk_bf16_f32 v147, v134, v135
    ds_write_b128 v213, v[144:147]
    v_cvt_pk_bf16_f32 v148, v136, v137
    v_cvt_pk_bf16_f32 v149, v138, v139
    v_cvt_pk_bf16_f32 v150, v140, v141
    v_cvt_pk_bf16_f32 v151, v142, v143
    ds_write_b128 v213, v[148:151] offset:1024
    v_add_f32 v219, v219, v132
    v_add_f32 v226, v226, v133
    v_add_f32 v219, v219, v134
    v_add_f32 v226, v226, v135
    v_add_f32 v219, v219, v136
    v_add_f32 v226, v226, v137
    v_add_f32 v219, v219, v138
    v_add_f32 v226, v226, v139
    v_add_f32 v219, v219, v140
    v_add_f32 v226, v226, v141
    v_add_f32 v219, v219, v142
    v_add_f32 v226, v226, v143
    v_add_f32 v219, v219, v226
    ds_write_b64 v215, v[218:219] offset:2048
    s_waitcnt lgkmcnt(0)
    s_barrier
    ds_read_b64 v[220:221], v216 offset:2048
    ds_read_b128 v[152:155], v214
    ds_read_b128 v[156:159], v214 offset:1024
    ds_read_b64_tr_b16 v[160:161], v192 offset:0
    ds_read_b64_tr_b16 v[162:163], v192 offset:4096
    ds_read_b64_tr_b16 v[164:165], v192 offset:8192
    ds_read_b64_tr_b16 v[166:167], v192 offset:12288
    ds_read_b64_tr_b16 v[168:169], v196 offset:0
    ds_read_b64_tr_b16 v[170:171], v196 offset:4096
    ds_read_b64_tr_b16 v[172:173], v196 offset:8192
    ds_read_b64_tr_b16 v[174:175], v196 offset:12288
    ds_read_b64_tr_b16 v[176:177], v193 offset:0
    ds_read_b64_tr_b16 v[178:179], v193 offset:4096
    ds_read_b64_tr_b16 v[180:181], v193 offset:8192
    ds_read_b64_tr_b16 v[182:183], v193 offset:12288
    s_waitcnt lgkmcnt(12)
    v_max_f32 v232, v218, v220
    v_cmp_gt_f32 vcc, v232, v225
    s_cbranch_vccnz L_rescB
    v_add_f32 v224, v224, v219
    v_add_f32 v224, v224, v221
L_rescBret:
    s_waitcnt lgkmcnt(10)
    v_mfma_f32_32x32x16_bf16 v[0:15], v[160:163], v[144:147], v[0:15]
    ds_read_b64_tr_b16 v[184:185], v197 offset:0
    ds_read_b64_tr_b16 v[186:187], v197 offset:4096
    s_waitcnt lgkmcnt(10)
    v_mfma_f32_32x32x16_bf16 v[0:15], v[164:167], v[148:151], v[0:15]
    ds_read_b64_tr_b16 v[188:189], v197 offset:8192
    ds_read_b64_tr_b16 v[190:191], v197 offset:12288
    s_waitcnt lgkmcnt(10)
    v_mfma_f32_32x32x16_bf16 v[0:15], v[168:171], v[152:155], v[0:15]
    ds_read_b64_tr_b16 v[160:161], v194 offset:0
    ds_read_b64_tr_b16 v[162:163], v194 offset:4096
    s_waitcnt lgkmcnt(10)
    v_mfma_f32_32x32x16_bf16 v[0:15], v[172:175], v[156:159], v[0:15]
    ds_read_b64_tr_b16 v[164:165], v194 offset:8192
    ds_read_b64_tr_b16 v[166:167], v194 offset:12288
    s_waitcnt lgkmcnt(10)
    v_mfma_f32_32x32x16_bf16 v[16:31], v[176:179], v[144:147], v[16:31]
    ds_read_b64_tr_b16 v[168:169], v198 offset:0
    ds_read_b64_tr_b16 v[170:171], v198 offset:4096
    s_waitcnt lgkmcnt(10)
    v_mfma_f32_32x32x16_bf16 v[16:31], v[180:183], v[148:151], v[16:31]
    ds_read_b64_tr_b16 v[172:173], v198 offset:8192
    ds_read_b64_tr_b16 v[174:175], v198 offset:12288
    s_waitcnt lgkmcnt(10)
    v_mfma_f32_32x32x16_bf16 v[16:31], v[184:187], v[152:155], v[16:31]
    ds_read_b64_tr_b16 v[176:177], v195 offset:0
    ds_read_b64_tr_b16 v[178:179], v195 offset:4096
    s_waitcnt lgkmcnt(10)
    v_mfma_f32_32x32x16_bf16 v[16:31], v[188:191], v[156:159], v[16:31]
    ds_read_b64_tr_b16 v[180:181], v195 offset:8192
    ds_read_b64_tr_b16 v[182:183], v195 offset:12288
    s_waitcnt lgkmcnt(10)
    v_mfma_f32_32x32x16_bf16 v[32:47], v[160:163], v[144:147], v[32:47]
    ds_read_b64_tr_b16 v[184:185], v199 offset:0
    ds_read_b64_tr_b16 v[186:187], v199 offset:4096
    s_waitcnt lgkmcnt(10)
    v_mfma_f32_32x32x16_bf16 v[32:47], v[164:167], v[148:151], v[32:47]
    ds_read_b64_tr_b16 v[188:189], v199 offset:8192
    ds_read_b64_tr_b16 v[190:191], v199 offset:12288
    s_waitcnt lgkmcnt(10)
    v_mfma_f32_32x32x16_bf16 v[32:47], v[168:171], v[152:155], v[32:47]
    s_waitcnt lgkmcnt(8)
    v_mfma_f32_32x32x16_bf16 v[32:47], v[172:175], v[156:159], v[32:47]
    s_waitcnt lgkmcnt(6)
    v_mfma_f32_32x32x16_bf16 v[48:63], v[176:179], v[144:147], v[48:63]
    s_waitcnt lgkmcnt(4)
    v_mfma_f32_32x32x16_bf16 v[48:63], v[180:183], v[148:151], v[48:63]
    s_waitcnt lgkmcnt(2)
    v_mfma_f32_32x32x16_bf16 v[48:63], v[184:187], v[152:155], v[48:63]
    s_waitcnt lgkmcnt(0)
    v_mfma_f32_32x32x16_bf16 v[48:63], v[188:191], v[156:159], v[48:63]
    s_add_u32 s33, s33, 32768
    s_and_b32 s33, s33, 0x1ffff
    s_sub_u32 s35, s35, 1
    s_cmp_lg_u32 s35, 0
    s_cbranch_scc1 L_loop
    v_cvt_pk_bf16_f32 v64, v0, v1
    v_cvt_pk_bf16_f32 v65, v2, v3
    v_cvt_pk_bf16_f32 v66, v4, v5
    v_cvt_pk_bf16_f32 v67, v6, v7
    ds_write_b128 v214, v[64:67] offset:0
    v_cvt_pk_bf16_f32 v68, v8, v9
    v_cvt_pk_bf16_f32 v69, v10, v11
    v_cvt_pk_bf16_f32 v70, v12, v13
    v_cvt_pk_bf16_f32 v71, v14, v15
    ds_write_b128 v214, v[68:71] offset:1024
    v_cvt_pk_bf16_f32 v72, v16, v17
    v_cvt_pk_bf16_f32 v73, v18, v19
    v_cvt_pk_bf16_f32 v74, v20, v21
    v_cvt_pk_bf16_f32 v75, v22, v23
    ds_write_b128 v214, v[72:75] offset:2048
    v_cvt_pk_bf16_f32 v76, v24, v25
    v_cvt_pk_bf16_f32 v77, v26, v27
    v_cvt_pk_bf16_f32 v78, v28, v29
    v_cvt_pk_bf16_f32 v79, v30, v31
    ds_write_b128 v214, v[76:79] offset:3072
    v_cvt_pk_bf16_f32 v80, v32, v33
    v_cvt_pk_bf16_f32 v81, v34, v35
    v_cvt_pk_bf16_f32 v82, v36, v37
    v_cvt_pk_bf16_f32 v83, v38, v39
    ds_write_b128 v214, v[80:83] offset:4096
    v_cvt_pk_bf16_f32 v84, v40, v41
    v_cvt_pk_bf16_f32 v85, v42, v43
    v_cvt_pk_bf16_f32 v86, v44, v45
    v_cvt_pk_bf16_f32 v87, v46, v47
    ds_write_b128 v214, v[84:87] offset:5120
    v_cvt_pk_bf16_f32 v88, v48, v49
    v_cvt_pk_bf16_f32 v89, v50, v51
    v_cvt_pk_bf16_f32 v90, v52, v53
    v_cvt_pk_bf16_f32 v91, v54, v55
    ds_write_b128 v214, v[88:91] offset:6144
    v_cvt_pk_bf16_f32 v92, v56, v57
    v_cvt_pk_bf16_f32 v93, v58, v59
    v_cvt_pk_bf16_f32 v94, v60, v61
    v_cvt_pk_bf16_f32 v95, v62, v63
    ds_write_b128 v214, v[92:95] offset:7168
    v_mov_b32 v192, v211
    v_xor_b32 v193, 16384, v211
    v_add_u32 v194, 0x10000, v192
    v_add_u32 v195, 0x10000, v193
    v_add_u32 v196, 0x20000, v192
    v_add_u32 v197, 0x20000, v193
    s_waitcnt lgkmcnt(0)
    s_barrier
    ds_read_b64_tr_b16 v[160:161], v194 offset:32768
    ds_read_b64_tr_b16 v[162:163], v194 offset:33792
    ds_read_b64_tr_b16 v[164:165], v194 offset:34816
    ds_read_b64_tr_b16 v[166:167], v194 offset:35840
    ds_read_b64_tr_b16 v[168:169], v194 offset:36864
    ds_read_b64_tr_b16 v[170:171], v194 offset:37888
    ds_read_b128 v[96:99], v213 offset:0
    ds_read_b128 v[100:103], v213 offset:1024
    ds_read_b128 v[104:107], v213 offset:2048
    ds_read_b128 v[108:111], v213 offset:3072
    ds_read_b128 v[112:115], v213 offset:4096
    ds_read_b128 v[116:119], v213 offset:5120
    ds_read_b128 v[120:123], v213 offset:6144
    ds_read_b128 v[124:127], v213 offset:7168
    ds_read_b64_tr_b16 v[172:173], v194 offset:38912
    ds_read_b64_tr_b16 v[174:175], v194 offset:39936
    ds_read_b64_tr_b16 v[176:177], v194 offset:40960
    ds_read_b64_tr_b16 v[178:179], v194 offset:41984
    ds_read_b64_tr_b16 v[180:181], v194 offset:43008
    ds_read_b64_tr_b16 v[182:183], v194 offset:44032
    v_mov_b32 v232, v224
    s_nop 1
    v_permlane32_swap_b32 v232, v224
    v_add_f32 v224, v224, v232
    v_rcp_f32 v224, v224
    s_lshl_b32 s46, s61, 13
    s_lshl_b32 s6, s32, 11
    s_add_u32 s46, s46, s6
    s_lshl_b32 s36, s61, 9
    s_mov_b32 s60, s61
    s_waitcnt lgkmcnt(15)
    v_mfma_f32_32x32x16_bf16 v[128:143], v[160:163], v[64:67], 0
    ds_read_b64_tr_b16 v[184:185], v194 offset:45056
    ds_read_b64_tr_b16 v[186:187], v194 offset:46080
    v_mfma_f32_32x32x16_bf16 v[128:143], v[164:167], v[68:71], v[128:143]
    ds_read_b64_tr_b16 v[188:189], v194 offset:47104
    ds_read_b64_tr_b16 v[190:191], v194 offset:48128
    s_waitcnt lgkmcnt(15)
    v_mfma_f32_32x32x16_bf16 v[128:143], v[168:171], v[72:75], v[128:143]
    ds_read_b64_tr_b16 v[160:161], v195 offset:32768
    ds_read_b64_tr_b16 v[162:163], v195 offset:33792
    s_waitcnt lgkmcnt(10)
    v_mfma_f32_32x32x16_bf16 v[128:143], v[172:175], v[76:79], v[128:143]
    ds_read_b64_tr_b16 v[164:165], v195 offset:34816
    ds_read_b64_tr_b16 v[166:167], v195 offset:35840
    s_waitcnt lgkmcnt(10)
    v_mfma_f32_32x32x16_bf16 v[128:143], v[176:179], v[80:83], v[128:143]
    ds_read_b64_tr_b16 v[168:169], v195 offset:36864
    ds_read_b64_tr_b16 v[170:171], v195 offset:37888
    s_waitcnt lgkmcnt(10)
    v_mfma_f32_32x32x16_bf16 v[128:143], v[180:183], v[84:87], v[128:143]
    ds_read_b64_tr_b16 v[172:173], v195 offset:38912
    ds_read_b64_tr_b16 v[174:175], v195 offset:39936
    s_waitcnt lgkmcnt(10)
    v_mfma_f32_32x32x16_bf16 v[128:143], v[184:187], v[88:91], v[128:143]
    ds_read_b64_tr_b16 v[176:177], v195 offset:40960
    ds_read_b64_tr_b16 v[178:179], v195 offset:41984
    s_waitcnt lgkmcnt(10)
    v_mfma_f32_32x32x16_bf16 v[128:143], v[188:191], v[92:95], v[128:143]
    ds_read_b64_tr_b16 v[180:181], v195 offset:43008
    ds_read_b64_tr_b16 v[182:183], v195 offset:44032
    s_waitcnt lgkmcnt(10)
    v_mfma_f32_32x32x16_bf16 v[128:143], v[160:163], v[96:99], v[128:143]
    ds_read_b64_tr_b16 v[184:185], v195 offset:45056
    ds_read_b64_tr_b16 v[186:187], v195 offset:46080
    s_waitcnt lgkmcnt(10)
    v_mfma_f32_32x32x16_bf16 v[128:143], v[164:167], v[100:103], v[128:143]
    ds_read_b64_tr_b16 v[188:189], v195 offset:47104
    ds_read_b64_tr_b16 v[190:191], v195 offset:48128
    s_waitcnt lgkmcnt(10)
    v_mfma_f32_32x32x16_bf16 v[128:143], v[168:171], v[104:107], v[128:143]
    s_barrier
    ds_read_b64_tr_b16 v[160:161], v192 offset:0
    ds_read_b64_tr_b16 v[162:163], v192 offset:1024
    s_waitcnt lgkmcnt(10)
    v_mfma_f32_32x32x16_bf16 v[128:143], v[172:175], v[108:111], v[128:143]
    ds_read_b64_tr_b16 v[164:165], v192 offset:2048
    ds_read_b64_tr_b16 v[166:167], v192 offset:3072
    s_waitcnt lgkmcnt(10)
    v_mfma_f32_32x32x16_bf16 v[128:143], v[176:179], v[112:115], v[128:143]
    ds_read_b64_tr_b16 v[168:169], v192 offset:4096
    ds_read_b64_tr_b16 v[170:171], v192 offset:5120
    s_waitcnt lgkmcnt(10)
    v_mfma_f32_32x32x16_bf16 v[128:143], v[180:183], v[116:119], v[128:143]
    ds_read_b64_tr_b16 v[172:173], v192 offset:6144
    ds_read_b64_tr_b16 v[174:175], v192 offset:7168
    s_waitcnt lgkmcnt(10)
    v_mfma_f32_32x32x16_bf16 v[128:143], v[184:187], v[120:123], v[128:143]
    ds_read_b64_tr_b16 v[176:177], v192 offset:8192
    ds_read_b64_tr_b16 v[178:179], v192 offset:9216
    s_waitcnt lgkmcnt(10)
    v_mfma_f32_32x32x16_bf16 v[128:143], v[188:191], v[124:127], v[128:143]
    ds_read_b64_tr_b16 v[180:181], v192 offset:10240
    ds_read_b64_tr_b16 v[182:183], v192 offset:11264
    s_waitcnt lgkmcnt(10)
    v_mfma_f32_32x32x16_bf16 v[0:15], v[160:163], v[64:67], 0
    ds_read_b64_tr_b16 v[184:185], v192 offset:12288
    ds_read_b64_tr_b16 v[186:187], v192 offset:13312
    s_waitcnt lgkmcnt(10)
    v_mfma_f32_32x32x16_bf16 v[0:15], v[164:167], v[68:71], v[0:15]
    ds_read_b64_tr_b16 v[188:189], v192 offset:14336
    ds_read_b64_tr_b16 v[190:191], v192 offset:15360
    s_nop 1
    v_mul_f32 v128, v128, v224
    v_mul_f32 v129, v129, v224
    v_mul_f32 v130, v130, v224
    s_waitcnt lgkmcnt(10)
    v_mfma_f32_32x32x16_bf16 v[0:15], v[168:171], v[72:75], v[0:15]
    ds_read_b64_tr_b16 v[160:161], v193 offset:0
    ds_read_b64_tr_b16 v[162:163], v193 offset:1024
    v_mul_f32 v131, v131, v224
    v_mul_f32 v132, v132, v224
    v_mul_f32 v133, v133, v224
    s_waitcnt lgkmcnt(10)
    v_mfma_f32_32x32x16_bf16 v[0:15], v[172:175], v[76:79], v[0:15]
    ds_read_b64_tr_b16 v[164:165], v193 offset:2048
    ds_read_b64_tr_b16 v[166:167], v193 offset:3072
    v_mul_f32 v134, v134, v224
    v_mul_f32 v135, v135, v224
    v_cvt_pk_bf16_f32 v144, v128, v129
    s_waitcnt lgkmcnt(10)
    v_mfma_f32_32x32x16_bf16 v[0:15], v[176:179], v[80:83], v[0:15]
    ds_read_b64_tr_b16 v[168:169], v193 offset:4096
    ds_read_b64_tr_b16 v[170:171], v193 offset:5120
    v_cvt_pk_bf16_f32 v145, v130, v131
    v_cvt_pk_bf16_f32 v146, v132, v133
    v_cvt_pk_bf16_f32 v147, v134, v135
    s_waitcnt lgkmcnt(10)
    v_mfma_f32_32x32x16_bf16 v[0:15], v[180:183], v[84:87], v[0:15]
    ds_read_b64_tr_b16 v[172:173], v193 offset:6144
    ds_read_b64_tr_b16 v[174:175], v193 offset:7168
    buffer_store_dwordx4 v[144:147], v227, s[28:31], s46 offen offset:0 sc1
    v_mul_f32 v136, v136, v224
    v_mul_f32 v137, v137, v224
    s_waitcnt lgkmcnt(10)
    v_mfma_f32_32x32x16_bf16 v[0:15], v[184:187], v[88:91], v[0:15]
    ds_read_b64_tr_b16 v[176:177], v193 offset:8192
    ds_read_b64_tr_b16 v[178:179], v193 offset:9216
    v_mul_f32 v138, v138, v224
    v_mul_f32 v139, v139, v224
    v_mul_f32 v140, v140, v224
    s_waitcnt lgkmcnt(10)
    v_mfma_f32_32x32x16_bf16 v[0:15], v[188:191], v[92:95], v[0:15]
    ds_read_b64_tr_b16 v[180:181], v193 offset:10240
    ds_read_b64_tr_b16 v[182:183], v193 offset:11264
    v_mul_f32 v141, v141, v224
    v_mul_f32 v142, v142, v224
    v_mul_f32 v143, v143, v224
    s_waitcnt lgkmcnt(10)
    v_mfma_f32_32x32x16_bf16 v[0:15], v[160:163], v[96:99], v[0:15]
    ds_read_b64_tr_b16 v[184:185], v193 offset:12288
    ds_read_b64_tr_b16 v[186:187], v193 offset:13312
    v_cvt_pk_bf16_f32 v148, v136, v137
    v_cvt_pk_bf16_f32 v149, v138, v139
    v_cvt_pk_bf16_f32 v150, v140, v141
    s_waitcnt lgkmcnt(10)
    v_mfma_f32_32x32x16_bf16 v[0:15], v[164:167], v[100:103], v[0:15]
    ds_read_b64_tr_b16 v[188:189], v193 offset:14336
    ds_read_b64_tr_b16 v[190:191], v193 offset:15360
    v_cvt_pk_bf16_f32 v151, v142, v143
    buffer_store_dwordx4 v[148:151], v227, s[28:31], s46 offen offset:1024 sc1
    s_add_u32 s46, s46, 8192
    s_add_u32 s61, s61, 1
    s_sub_u32 s6, s46, 57344
    s_cmp_lt_u32 s61, 7
    s_cselect_b32 s46, s46, s6
    s_cselect_b32 s61, s61, 0
    s_waitcnt lgkmcnt(10)
    v_mfma_f32_32x32x16_bf16 v[0:15], v[168:171], v[104:107], v[0:15]
    s_barrier
    ds_read_b64_tr_b16 v[160:161], v192 offset:32768
    ds_read_b64_tr_b16 v[162:163], v192 offset:33792
    s_waitcnt lgkmcnt(10)
    v_mfma_f32_32x32x16_bf16 v[0:15], v[172:175], v[108:111], v[0:15]
    ds_read_b64_tr_b16 v[164:165], v192 offset:34816
    ds_read_b64_tr_b16 v[166:167], v192 offset:35840
    s_waitcnt lgkmcnt(10)
    v_mfma_f32_32x32x16_bf16 v[0:15], v[176:179], v[112:115], v[0:15]
    ds_read_b64_tr_b16 v[168:169], v192 offset:36864
    ds_read_b64_tr_b16 v[170:171], v192 offset:37888
    s_waitcnt lgkmcnt(10)
    v_mfma_f32_32x32x16_bf16 v[0:15], v[180:183], v[116:119], v[0:15]
    ds_read_b64_tr_b16 v[172:173], v192 offset:38912
    ds_read_b64_tr_b16 v[174:175], v192 offset:39936
    s_waitcnt lgkmcnt(10)
    v_mfma_f32_32x32x16_bf16 v[0:15], v[184:187], v[120:123], v[0:15]
    ds_read_b64_tr_b16 v[176:177], v192 offset:40960
    ds_read_b64_tr_b16 v[178:179], v192 offset:41984
    s_waitcnt lgkmcnt(10)
    v_mfma_f32_32x32x16_bf16 v[0:15], v[188:191], v[124:127], v[0:15]
    ds_read_b64_tr_b16 v[180:181], v192 offset:43008
    ds_read_b64_tr_b16 v[182:183], v192 offset:44032
    s_waitcnt lgkmcnt(10)
    v_mfma_f32_32x32x16_bf16 v[128:143], v[160:163], v[64:67], 0
    ds_read_b64_tr_b16 v[184:185], v192 offset:45056
    ds_read_b64_tr_b16 v[186:187], v192 offset:46080
    s_waitcnt lgkmcnt(10)
    v_mfma_f32_32x32x16_bf16 v[128:143], v[164:167], v[68:71], v[128:143]
    ds_read_b64_tr_b16 v[188:189], v192 offset:47104
    ds_read_b64_tr_b16 v[190:191], v192 offset:48128
    s_nop 1
    v_mul_f32 v0, v0, v224
    v_mul_f32 v1, v1, v224
    v_mul_f32 v2, v2, v224
    s_waitcnt lgkmcnt(10)
    v_mfma_f32_32x32x16_bf16 v[128:143], v[168:171], v[72:75], v[128:143]
    ds_read_b64_tr_b16 v[160:161], v193 offset:32768
    ds_read_b64_tr_b16 v[162:163], v193 offset:33792
    v_mul_f32 v3, v3, v224
    v_mul_f32 v4, v4, v224
    v_mul_f32 v5, v5, v224
    s_waitcnt lgkmcnt(10)
    v_mfma_f32_32x32x16_bf16 v[128:143], v[172:175], v[76:79], v[128:143]
    ds_read_b64_tr_b16 v[164:165], v193 offset:34816
    ds_read_b64_tr_b16 v[166:167], v193 offset:35840
    v_mul_f32 v6, v6, v224
    v_mul_f32 v7, v7, v224
    v_cvt_pk_bf16_f32 v144, v0, v1
    s_waitcnt lgkmcnt(10)
    v_mfma_f32_32x32x16_bf16 v[128:143], v[176:179], v[80:83], v[128:143]
    ds_read_b64_tr_b16 v[168:169], v193 offset:36864
    ds_read_b64_tr_b16 v[170:171], v193 offset:37888
    v_cvt_pk_bf16_f32 v145, v2, v3
    v_cvt_pk_bf16_f32 v146, v4, v5
    v_cvt_pk_bf16_f32 v147, v6, v7
    s_waitcnt lgkmcnt(10)
    v_mfma_f32_32x32x16_bf16 v[128:143], v[180:183], v[84:87], v[128:143]
    ds_read_b64_tr_b16 v[172:173], v193 offset:38912
    ds_read_b64_tr_b16 v[174:175], v193 offset:39936
    buffer_store_dwordx4 v[144:147], v227, s[28:31], s46 offen offset:0 sc1
    v_mul_f32 v8, v8, v224
    v_mul_f32 v9, v9, v224
    s_waitcnt lgkmcnt(10)
    v_mfma_f32_32x32x16_bf16 v[128:143], v[184:187], v[88:91], v[128:143]
    ds_read_b64_tr_b16 v[176:177], v193 offset:40960
    ds_read_b64_tr_b16 v[178:179], v193 offset:41984
    v_mul_f32 v10, v10, v224
    v_mul_f32 v11, v11, v224
    v_mul_f32 v12, v12, v224
    s_waitcnt lgkmcnt(10)
    v_mfma_f32_32x32x16_bf16 v[128:143], v[188:191], v[92:95], v[128:143]
    ds_read_b64_tr_b16 v[180:181], v193 offset:43008
    ds_read_b64_tr_b16 v[182:183], v193 offset:44032
    v_mul_f32 v13, v13, v224
    v_mul_f32 v14, v14, v224
    v_mul_f32 v15, v15, v224
    s_waitcnt lgkmcnt(10)
    v_mfma_f32_32x32x16_bf16 v[128:143], v[160:163], v[96:99], v[128:143]
    ds_read_b64_tr_b16 v[184:185], v193 offset:45056
    ds_read_b64_tr_b16 v[186:187], v193 offset:46080
    v_cvt_pk_bf16_f32 v148, v8, v9
    v_cvt_pk_bf16_f32 v149, v10, v11
    v_cvt_pk_bf16_f32 v150, v12, v13
    s_waitcnt lgkmcnt(10)
    v_mfma_f32_32x32x16_bf16 v[128:143], v[164:167], v[100:103], v[128:143]
    ds_read_b64_tr_b16 v[188:189], v193 offset:47104
    ds_read_b64_tr_b16 v[190:191], v193 offset:48128
    v_cvt_pk_bf16_f32 v151, v14, v15
    buffer_store_dwordx4 v[148:151], v227, s[28:31], s46 offen offset:1024 sc1
    s_add_u32 s46, s46, 8192
    s_add_u32 s61, s61, 1
    s_sub_u32 s6, s46, 57344
    s_cmp_lt_u32 s61, 7
    s_cselect_b32 s46, s46, s6
    s_cselect_b32 s61, s61, 0
    s_waitcnt lgkmcnt(10)
    v_mfma_f32_32x32x16_bf16 v[128:143], v[168:171], v[104:107], v[128:143]
    s_barrier
    ds_read_b64_tr_b16 v[160:161], v194 offset:0
    ds_read_b64_tr_b16 v[162:163], v194 offset:1024
    s_waitcnt lgkmcnt(10)
    v_mfma_f32_32x32x16_bf16 v[128:143], v[172:175], v[108:111], v[128:143]
    ds_read_b64_tr_b16 v[164:165], v194 offset:2048
    ds_read_b64_tr_b16 v[166:167], v194 offset:3072
    s_waitcnt lgkmcnt(10)
    v_mfma_f32_32x32x16_bf16 v[128:143], v[176:179], v[112:115], v[128:143]
    ds_read_b64_tr_b16 v[168:169], v194 offset:4096
    ds_read_b64_tr_b16 v[170:171], v194 offset:5120
    s_waitcnt lgkmcnt(10)
    v_mfma_f32_32x32x16_bf16 v[128:143], v[180:183], v[116:119], v[128:143]
    ds_read_b64_tr_b16 v[172:173], v194 offset:6144
    ds_read_b64_tr_b16 v[174:175], v194 offset:7168
    s_waitcnt lgkmcnt(10)
    v_mfma_f32_32x32x16_bf16 v[128:143], v[184:187], v[120:123], v[128:143]
    ds_read_b64_tr_b16 v[176:177], v194 offset:8192
    ds_read_b64_tr_b16 v[178:179], v194 offset:9216
    s_waitcnt lgkmcnt(10)
    v_mfma_f32_32x32x16_bf16 v[128:143], v[188:191], v[124:127], v[128:143]
    ds_read_b64_tr_b16 v[180:181], v194 offset:10240
    ds_read_b64_tr_b16 v[182:183], v194 offset:11264
    s_waitcnt lgkmcnt(10)
    v_mfma_f32_32x32x16_bf16 v[0:15], v[160:163], v[64:67], 0
    ds_read_b64_tr_b16 v[184:185], v194 offset:12288
    ds_read_b64_tr_b16 v[186:187], v194 offset:13312
    s_waitcnt lgkmcnt(10)
    v_mfma_f32_32x32x16_bf16 v[0:15], v[164:167], v[68:71], v[0:15]
    ds_read_b64_tr_b16 v[188:189], v194 offset:14336
    ds_read_b64_tr_b16 v[190:191], v194 offset:15360
    s_nop 1
    v_mul_f32 v128, v128, v224
    v_mul_f32 v129, v129, v224
    v_mul_f32 v130, v130, v224
    s_waitcnt lgkmcnt(10)
    v_mfma_f32_32x32x16_bf16 v[0:15], v[168:171], v[72:75], v[0:15]
    ds_read_b64_tr_b16 v[160:161], v195 offset:0
    ds_read_b64_tr_b16 v[162:163], v195 offset:1024
    v_mul_f32 v131, v131, v224
    v_mul_f32 v132, v132, v224
    v_mul_f32 v133, v133, v224
    s_waitcnt lgkmcnt(10)
    v_mfma_f32_32x32x16_bf16 v[0:15], v[172:175], v[76:79], v[0:15]
    ds_read_b64_tr_b16 v[164:165], v195 offset:2048
    ds_read_b64_tr_b16 v[166:167], v195 offset:3072
    v_mul_f32 v134, v134, v224
    v_mul_f32 v135, v135, v224
    v_cvt_pk_bf16_f32 v144, v128, v129
    s_waitcnt lgkmcnt(10)
    v_mfma_f32_32x32x16_bf16 v[0:15], v[176:179], v[80:83], v[0:15]
    ds_read_b64_tr_b16 v[168:169], v195 offset:4096
    ds_read_b64_tr_b16 v[170:171], v195 offset:5120
    v_cvt_pk_bf16_f32 v145, v130, v131
    v_cvt_pk_bf16_f32 v146, v132, v133
    v_cvt_pk_bf16_f32 v147, v134, v135
    s_waitcnt lgkmcnt(10)
    v_mfma_f32_32x32x16_bf16 v[0:15], v[180:183], v[84:87], v[0:15]
    ds_read_b64_tr_b16 v[172:173], v195 offset:6144
    ds_read_b64_tr_b16 v[174:175], v195 offset:7168
    buffer_store_dwordx4 v[144:147], v227, s[28:31], s46 offen offset:0 sc1
    v_mul_f32 v136, v136, v224
    v_mul_f32 v137, v137, v224
    s_waitcnt lgkmcnt(10)
    v_mfma_f32_32x32x16_bf16 v[0:15], v[184:187], v[88:91], v[0:15]
    ds_read_b64_tr_b16 v[176:177], v195 offset:8192
    ds_read_b64_tr_b16 v[178:179], v195 offset:9216
    v_mul_f32 v138, v138, v224
    v_mul_f32 v139, v139, v224
    v_mul_f32 v140, v140, v224
    s_waitcnt lgkmcnt(10)
    v_mfma_f32_32x32x16_bf16 v[0:15], v[188:191], v[92:95], v[0:15]
    ds_read_b64_tr_b16 v[180:181], v195 offset:10240
    ds_read_b64_tr_b16 v[182:183], v195 offset:11264
    v_mul_f32 v141, v141, v224
    v_mul_f32 v142, v142, v224
    v_mul_f32 v143, v143, v224
    s_waitcnt lgkmcnt(10)
    v_mfma_f32_32x32x16_bf16 v[0:15], v[160:163], v[96:99], v[0:15]
    ds_read_b64_tr_b16 v[184:185], v195 offset:12288
    ds_read_b64_tr_b16 v[186:187], v195 offset:13312
    v_cvt_pk_bf16_f32 v148, v136, v137
    v_cvt_pk_bf16_f32 v149, v138, v139
    v_cvt_pk_bf16_f32 v150, v140, v141
    s_waitcnt lgkmcnt(10)
    v_mfma_f32_32x32x16_bf16 v[0:15], v[164:167], v[100:103], v[0:15]
    ds_read_b64_tr_b16 v[188:189], v195 offset:14336
    ds_read_b64_tr_b16 v[190:191], v195 offset:15360
    v_cvt_pk_bf16_f32 v151, v142, v143
    buffer_store_dwordx4 v[148:151], v227, s[28:31], s46 offen offset:1024 sc1
    s_add_u32 s46, s46, 8192
    s_add_u32 s61, s61, 1
    s_sub_u32 s6, s46, 57344
    s_cmp_lt_u32 s61, 7
    s_cselect_b32 s46, s46, s6
    s_cselect_b32 s61, s61, 0
    s_waitcnt lgkmcnt(10)
    v_mfma_f32_32x32x16_bf16 v[0:15], v[168:171], v[104:107], v[0:15]
    s_barrier
    ds_read_b64_tr_b16 v[160:161], v196 offset:0
    ds_read_b64_tr_b16 v[162:163], v196 offset:1024
    s_waitcnt lgkmcnt(10)
    v_mfma_f32_32x32x16_bf16 v[0:15], v[172:175], v[108:111], v[0:15]
    ds_read_b64_tr_b16 v[164:165], v196 offset:2048
    ds_read_b64_tr_b16 v[166:167], v196 offset:3072
    s_waitcnt lgkmcnt(10)
    v_mfma_f32_32x32x16_bf16 v[0:15], v[176:179], v[112:115], v[0:15]
    ds_read_b64_tr_b16 v[168:169], v196 offset:4096
    ds_read_b64_tr_b16 v[170:171], v196 offset:5120
    s_waitcnt lgkmcnt(10)
    v_mfma_f32_32x32x16_bf16 v[0:15], v[180:183], v[116:119], v[0:15]
    ds_read_b64_tr_b16 v[172:173], v196 offset:6144
    ds_read_b64_tr_b16 v[174:175], v196 offset:7168
    s_waitcnt lgkmcnt(10)
    v_mfma_f32_32x32x16_bf16 v[0:15], v[184:187], v[120:123], v[0:15]
    ds_read_b64_tr_b16 v[176:177], v196 offset:8192
    ds_read_b64_tr_b16 v[178:179], v196 offset:9216
    s_waitcnt lgkmcnt(10)
    v_mfma_f32_32x32x16_bf16 v[0:15], v[188:191], v[124:127], v[0:15]
    ds_read_b64_tr_b16 v[180:181], v196 offset:10240
    ds_read_b64_tr_b16 v[182:183], v196 offset:11264
    s_waitcnt lgkmcnt(10)
    v_mfma_f32_32x32x16_bf16 v[128:143], v[160:163], v[64:67], 0
    ds_read_b64_tr_b16 v[184:185], v196 offset:12288
    ds_read_b64_tr_b16 v[186:187], v196 offset:13312
    s_waitcnt lgkmcnt(10)
    v_mfma_f32_32x32x16_bf16 v[128:143], v[164:167], v[68:71], v[128:143]
    ds_read_b64_tr_b16 v[188:189], v196 offset:14336
    ds_read_b64_tr_b16 v[190:191], v196 offset:15360
    s_nop 1
    v_mul_f32 v0, v0, v224
    v_mul_f32 v1, v1, v224
    v_mul_f32 v2, v2, v224
    s_waitcnt lgkmcnt(10)
    v_mfma_f32_32x32x16_bf16 v[128:143], v[168:171], v[72:75], v[128:143]
    ds_read_b64_tr_b16 v[160:161], v197 offset:0
    ds_read_b64_tr_b16 v[162:163], v197 offset:1024
    v_mul_f32 v3, v3, v224
    v_mul_f32 v4, v4, v224
    v_mul_f32 v5, v5, v224
    s_waitcnt lgkmcnt(10)
    v_mfma_f32_32x32x16_bf16 v[128:143], v[172:175], v[76:79], v[128:143]
    ds_read_b64_tr_b16 v[164:165], v197 offset:2048
    ds_read_b64_tr_b16 v[166:167], v197 offset:3072
    v_mul_f32 v6, v6, v224
    v_mul_f32 v7, v7, v224
    v_cvt_pk_bf16_f32 v144, v0, v1
    s_waitcnt lgkmcnt(10)
    v_mfma_f32_32x32x16_bf16 v[128:143], v[176:179], v[80:83], v[128:143]
    ds_read_b64_tr_b16 v[168:169], v197 offset:4096
    ds_read_b64_tr_b16 v[170:171], v197 offset:5120
    v_cvt_pk_bf16_f32 v145, v2, v3
    v_cvt_pk_bf16_f32 v146, v4, v5
    v_cvt_pk_bf16_f32 v147, v6, v7
    s_waitcnt lgkmcnt(10)
    v_mfma_f32_32x32x16_bf16 v[128:143], v[180:183], v[84:87], v[128:143]
    ds_read_b64_tr_b16 v[172:173], v197 offset:6144
    ds_read_b64_tr_b16 v[174:175], v197 offset:7168
    buffer_store_dwordx4 v[144:147], v227, s[28:31], s46 offen offset:0 sc1
    v_mul_f32 v8, v8, v224
    v_mul_f32 v9, v9, v224
    s_waitcnt lgkmcnt(10)
    v_mfma_f32_32x32x16_bf16 v[128:143], v[184:187], v[88:91], v[128:143]
    ds_read_b64_tr_b16 v[176:177], v197 offset:8192
    ds_read_b64_tr_b16 v[178:179], v197 offset:9216
    v_mul_f32 v10, v10, v224
    v_mul_f32 v11, v11, v224
    v_mul_f32 v12, v12, v224
    s_waitcnt lgkmcnt(10)
    v_mfma_f32_32x32x16_bf16 v[128:143], v[188:191], v[92:95], v[128:143]
    ds_read_b64_tr_b16 v[180:181], v197 offset:10240
    ds_read_b64_tr_b16 v[182:183], v197 offset:11264
    v_mul_f32 v13, v13, v224
    v_mul_f32 v14, v14, v224
    v_mul_f32 v15, v15, v224
    s_waitcnt lgkmcnt(10)
    v_mfma_f32_32x32x16_bf16 v[128:143], v[160:163], v[96:99], v[128:143]
    ds_read_b64_tr_b16 v[184:185], v197 offset:12288
    ds_read_b64_tr_b16 v[186:187], v197 offset:13312
    v_cvt_pk_bf16_f32 v148, v8, v9
    v_cvt_pk_bf16_f32 v149, v10, v11
    v_cvt_pk_bf16_f32 v150, v12, v13
    s_waitcnt lgkmcnt(10)
    v_mfma_f32_32x32x16_bf16 v[128:143], v[164:167], v[100:103], v[128:143]
    ds_read_b64_tr_b16 v[188:189], v197 offset:14336
    ds_read_b64_tr_b16 v[190:191], v197 offset:15360
    v_cvt_pk_bf16_f32 v151, v14, v15
    buffer_store_dwordx4 v[148:151], v227, s[28:31], s46 offen offset:1024 sc1
    s_add_u32 s46, s46, 8192
    s_add_u32 s61, s61, 1
    s_sub_u32 s6, s46, 57344
    s_cmp_lt_u32 s61, 7
    s_cselect_b32 s46, s46, s6
    s_cselect_b32 s61, s61, 0
    s_waitcnt lgkmcnt(10)
    v_mfma_f32_32x32x16_bf16 v[128:143], v[168:171], v[104:107], v[128:143]
    s_barrier
    ds_read_b64_tr_b16 v[160:161], v194 offset:32768
    ds_read_b64_tr_b16 v[162:163], v194 offset:33792
    s_waitcnt vmcnt(6)
    s_call_b64 s[40:41], L_flag
    s_waitcnt lgkmcnt(10)
    v_mfma_f32_32x32x16_bf16 v[128:143], v[172:175], v[108:111], v[128:143]
    ds_read_b64_tr_b16 v[164:165], v194 offset:34816
    ds_read_b64_tr_b16 v[166:167], v194 offset:35840
    s_waitcnt lgkmcnt(10)
    v_mfma_f32_32x32x16_bf16 v[128:143], v[176:179], v[112:115], v[128:143]
    ds_read_b64_tr_b16 v[168:169], v194 offset:36864
    ds_read_b64_tr_b16 v[170:171], v194 offset:37888
    s_waitcnt lgkmcnt(10)
    v_mfma_f32_32x32x16_bf16 v[128:143], v[180:183], v[116:119], v[128:143]
    ds_read_b64_tr_b16 v[172:173], v194 offset:38912
    ds_read_b64_tr_b16 v[174:175], v194 offset:39936
    s_waitcnt lgkmcnt(10)
    v_mfma_f32_32x32x16_bf16 v[128:143], v[184:187], v[120:123], v[128:143]
    ds_read_b64_tr_b16 v[176:177], v194 offset:40960
    ds_read_b64_tr_b16 v[178:179], v194 offset:41984
    s_waitcnt lgkmcnt(10)
    v_mfma_f32_32x32x16_bf16 v[128:143], v[188:191], v[124:127], v[128:143]
    ds_read_b64_tr_b16 v[180:181], v194 offset:43008
    ds_read_b64_tr_b16 v[182:183], v194 offset:44032
    s_waitcnt lgkmcnt(10)
    v_mfma_f32_32x32x16_bf16 v[0:15], v[160:163], v[64:67], 0
    ds_read_b64_tr_b16 v[184:185], v194 offset:45056
    ds_read_b64_tr_b16 v[186:187], v194 offset:46080
    s_waitcnt lgkmcnt(10)
    v_mfma_f32_32x32x16_bf16 v[0:15], v[164:167], v[68:71], v[0:15]
    ds_read_b64_tr_b16 v[188:189], v194 offset:47104
    ds_read_b64_tr_b16 v[190:191], v194 offset:48128
    s_nop 1
    v_mul_f32 v128, v128, v224
    v_mul_f32 v129, v129, v224
    v_mul_f32 v130, v130, v224
    s_waitcnt lgkmcnt(10)
    v_mfma_f32_32x32x16_bf16 v[0:15], v[168:171], v[72:75], v[0:15]
    ds_read_b64_tr_b16 v[160:161], v195 offset:32768
    ds_read_b64_tr_b16 v[162:163], v195 offset:33792
    v_mul_f32 v131, v131, v224
    v_mul_f32 v132, v132, v224
    v_mul_f32 v133, v133, v224
    s_waitcnt lgkmcnt(10)
    v_mfma_f32_32x32x16_bf16 v[0:15], v[172:175], v[76:79], v[0:15]
    ds_read_b64_tr_b16 v[164:165], v195 offset:34816
    ds_read_b64_tr_b16 v[166:167], v195 offset:35840
    v_mul_f32 v134, v134, v224
    v_mul_f32 v135, v135, v224
    v_cvt_pk_bf16_f32 v144, v128, v129
    s_waitcnt lgkmcnt(10)
    v_mfma_f32_32x32x16_bf16 v[0:15], v[176:179], v[80:83], v[0:15]
    ds_read_b64_tr_b16 v[168:169], v195 offset:36864
    ds_read_b64_tr_b16 v[170:171], v195 offset:37888
    v_cvt_pk_bf16_f32 v145, v130, v131
    v_cvt_pk_bf16_f32 v146, v132, v133
    v_cvt_pk_bf16_f32 v147, v134, v135
    s_waitcnt lgkmcnt(10)
    v_mfma_f32_32x32x16_bf16 v[0:15], v[180:183], v[84:87], v[0:15]
    ds_read_b64_tr_b16 v[172:173], v195 offset:38912
    ds_read_b64_tr_b16 v[174:175], v195 offset:39936
    buffer_store_dwordx4 v[144:147], v227, s[28:31], s46 offen offset:0 sc1
    v_mul_f32 v136, v136, v224
    v_mul_f32 v137, v137, v224
    s_waitcnt lgkmcnt(10)
    v_mfma_f32_32x32x16_bf16 v[0:15], v[184:187], v[88:91], v[0:15]
    ds_read_b64_tr_b16 v[176:177], v195 offset:40960
    ds_read_b64_tr_b16 v[178:179], v195 offset:41984
    v_mul_f32 v138, v138, v224
    v_mul_f32 v139, v139, v224
    v_mul_f32 v140, v140, v224
    s_waitcnt lgkmcnt(10)
    v_mfma_f32_32x32x16_bf16 v[0:15], v[188:191], v[92:95], v[0:15]
    ds_read_b64_tr_b16 v[180:181], v195 offset:43008
    ds_read_b64_tr_b16 v[182:183], v195 offset:44032
    v_mul_f32 v141, v141, v224
    v_mul_f32 v142, v142, v224
    v_mul_f32 v143, v143, v224
    s_waitcnt lgkmcnt(10)
    v_mfma_f32_32x32x16_bf16 v[0:15], v[160:163], v[96:99], v[0:15]
    ds_read_b64_tr_b16 v[184:185], v195 offset:45056
    ds_read_b64_tr_b16 v[186:187], v195 offset:46080
    v_cvt_pk_bf16_f32 v148, v136, v137
    v_cvt_pk_bf16_f32 v149, v138, v139
    v_cvt_pk_bf16_f32 v150, v140, v141
    s_waitcnt lgkmcnt(10)
    v_mfma_f32_32x32x16_bf16 v[0:15], v[164:167], v[100:103], v[0:15]
    ds_read_b64_tr_b16 v[188:189], v195 offset:47104
    ds_read_b64_tr_b16 v[190:191], v195 offset:48128
    v_cvt_pk_bf16_f32 v151, v142, v143
    buffer_store_dwordx4 v[148:151], v227, s[28:31], s46 offen offset:1024 sc1
    s_add_u32 s46, s46, 8192
    s_add_u32 s61, s61, 1
    s_sub_u32 s6, s46, 57344
    s_cmp_lt_u32 s61, 7
    s_cselect_b32 s46, s46, s6
    s_cselect_b32 s61, s61, 0
    s_waitcnt lgkmcnt(10)
    v_mfma_f32_32x32x16_bf16 v[0:15], v[168:171], v[104:107], v[0:15]
    s_barrier
    ds_read_b64_tr_b16 v[160:161], v192 offset:0
    ds_read_b64_tr_b16 v[162:163], v192 offset:1024
    s_waitcnt vmcnt(7)
    s_call_b64 s[40:41], L_flag
    s_waitcnt lgkmcnt(10)
    v_mfma_f32_32x32x16_bf16 v[0:15], v[172:175], v[108:111], v[0:15]
    ds_read_b64_tr_b16 v[164:165], v192 offset:2048
    ds_read_b64_tr_b16 v[166:167], v192 offset:3072
    s_waitcnt lgkmcnt(10)
    v_mfma_f32_32x32x16_bf16 v[0:15], v[176:179], v[112:115], v[0:15]
    ds_read_b64_tr_b16 v[168:169], v192 offset:4096
    ds_read_b64_tr_b16 v[170:171], v192 offset:5120
    s_waitcnt lgkmcnt(10)
    v_mfma_f32_32x32x16_bf16 v[0:15], v[180:183], v[116:119], v[0:15]
    ds_read_b64_tr_b16 v[172:173], v192 offset:6144
    ds_read_b64_tr_b16 v[174:175], v192 offset:7168
    s_waitcnt lgkmcnt(10)
    v_mfma_f32_32x32x16_bf16 v[0:15], v[184:187], v[120:123], v[0:15]
    ds_read_b64_tr_b16 v[176:177], v192 offset:8192
    ds_read_b64_tr_b16 v[178:179], v192 offset:9216
    s_waitcnt lgkmcnt(10)
    v_mfma_f32_32x32x16_bf16 v[0:15], v[188:191], v[124:127], v[0:15]
    ds_read_b64_tr_b16 v[180:181], v192 offset:10240
    ds_read_b64_tr_b16 v[182:183], v192 offset:11264
    s_waitcnt lgkmcnt(10)
    v_mfma_f32_32x32x16_bf16 v[128:143], v[160:163], v[64:67], 0
    ds_read_b64_tr_b16 v[184:185], v192 offset:12288
    ds_read_b64_tr_b16 v[186:187], v192 offset:13312
    s_waitcnt lgkmcnt(10)
    v_mfma_f32_32x32x16_bf16 v[128:143], v[164:167], v[68:71], v[128:143]
    ds_read_b64_tr_b16 v[188:189], v192 offset:14336
    ds_read_b64_tr_b16 v[190:191], v192 offset:15360
    s_nop 1
    v_mul_f32 v0, v0, v224
    v_mul_f32 v1, v1, v224
    v_mul_f32 v2, v2, v224
    s_waitcnt lgkmcnt(10)
    v_mfma_f32_32x32x16_bf16 v[128:143], v[168:171], v[72:75], v[128:143]
    ds_read_b64_tr_b16 v[160:161], v193 offset:0
    ds_read_b64_tr_b16 v[162:163], v193 offset:1024
    v_mul_f32 v3, v3, v224
    v_mul_f32 v4, v4, v224
    v_mul_f32 v5, v5, v224
    s_waitcnt lgkmcnt(10)
    v_mfma_f32_32x32x16_bf16 v[128:143], v[172:175], v[76:79], v[128:143]
    ds_read_b64_tr_b16 v[164:165], v193 offset:2048
    ds_read_b64_tr_b16 v[166:167], v193 offset:3072
    v_mul_f32 v6, v6, v224
    v_mul_f32 v7, v7, v224
    v_cvt_pk_bf16_f32 v144, v0, v1
    s_waitcnt lgkmcnt(10)
    v_mfma_f32_32x32x16_bf16 v[128:143], v[176:179], v[80:83], v[128:143]
    ds_read_b64_tr_b16 v[168:169], v193 offset:4096
    ds_read_b64_tr_b16 v[170:171], v193 offset:5120
    v_cvt_pk_bf16_f32 v145, v2, v3
    v_cvt_pk_bf16_f32 v146, v4, v5
    v_cvt_pk_bf16_f32 v147, v6, v7
    s_waitcnt lgkmcnt(10)
    v_mfma_f32_32x32x16_bf16 v[128:143], v[180:183], v[84:87], v[128:143]
    ds_read_b64_tr_b16 v[172:173], v193 offset:6144
    ds_read_b64_tr_b16 v[174:175], v193 offset:7168
    buffer_store_dwordx4 v[144:147], v227, s[28:31], s46 offen offset:0 sc1
    v_mul_f32 v8, v8, v224
    v_mul_f32 v9, v9, v224
    s_waitcnt lgkmcnt(10)
    v_mfma_f32_32x32x16_bf16 v[128:143], v[184:187], v[88:91], v[128:143]
    ds_read_b64_tr_b16 v[176:177], v193 offset:8192
    ds_read_b64_tr_b16 v[178:179], v193 offset:9216
    v_mul_f32 v10, v10, v224
    v_mul_f32 v11, v11, v224
    v_mul_f32 v12, v12, v224
    s_waitcnt lgkmcnt(10)
    v_mfma_f32_32x32x16_bf16 v[128:143], v[188:191], v[92:95], v[128:143]
    ds_read_b64_tr_b16 v[180:181], v193 offset:10240
    ds_read_b64_tr_b16 v[182:183], v193 offset:11264
    v_mul_f32 v13, v13, v224
    v_mul_f32 v14, v14, v224
    v_mul_f32 v15, v15, v224
    s_waitcnt lgkmcnt(10)
    v_mfma_f32_32x32x16_bf16 v[128:143], v[160:163], v[96:99], v[128:143]
    ds_read_b64_tr_b16 v[184:185], v193 offset:12288
    ds_read_b64_tr_b16 v[186:187], v193 offset:13312
    v_cvt_pk_bf16_f32 v148, v8, v9
    v_cvt_pk_bf16_f32 v149, v10, v11
    v_cvt_pk_bf16_f32 v150, v12, v13
    s_waitcnt lgkmcnt(10)
    v_mfma_f32_32x32x16_bf16 v[128:143], v[164:167], v[100:103], v[128:143]
    ds_read_b64_tr_b16 v[188:189], v193 offset:14336
    ds_read_b64_tr_b16 v[190:191], v193 offset:15360
    v_cvt_pk_bf16_f32 v151, v14, v15
    buffer_store_dwordx4 v[148:151], v227, s[28:31], s46 offen offset:1024 sc1
    s_add_u32 s46, s46, 8192
    s_add_u32 s61, s61, 1
    s_sub_u32 s6, s46, 57344
    s_cmp_lt_u32 s61, 7
    s_cselect_b32 s46, s46, s6
    s_cselect_b32 s61, s61, 0
    s_waitcnt lgkmcnt(10)
    v_mfma_f32_32x32x16_bf16 v[128:143], v[168:171], v[104:107], v[128:143]
    s_waitcnt vmcnt(8)
    s_call_b64 s[40:41], L_flag
    s_waitcnt lgkmcnt(8)
    v_mfma_f32_32x32x16_bf16 v[128:143], v[172:175], v[108:111], v[128:143]
    s_waitcnt lgkmcnt(6)
    v_mfma_f32_32x32x16_bf16 v[128:143], v[176:179], v[112:115], v[128:143]
    s_waitcnt lgkmcnt(4)
    v_mfma_f32_32x32x16_bf16 v[128:143], v[180:183], v[116:119], v[128:143]
    s_waitcnt lgkmcnt(2)
    v_mfma_f32_32x32x16_bf16 v[128:143], v[184:187], v[120:123], v[128:143]
    s_waitcnt lgkmcnt(0)
    v_mfma_f32_32x32x16_bf16 v[128:143], v[188:191], v[124:127], v[128:143]
    s_nop 11
    v_mul_f32 v128, v128, v224
    v_mul_f32 v129, v129, v224
    v_mul_f32 v130, v130, v224
    v_mul_f32 v131, v131, v224
    v_mul_f32 v132, v132, v224
    v_mul_f32 v133, v133, v224
    v_mul_f32 v134, v134, v224
    v_mul_f32 v135, v135, v224
    v_cvt_pk_bf16_f32 v144, v128, v129
    v_cvt_pk_bf16_f32 v145, v130, v131
    v_cvt_pk_bf16_f32 v146, v132, v133
    v_cvt_pk_bf16_f32 v147, v134, v135
    buffer_store_dwordx4 v[144:147], v227, s[28:31], s46 offen offset:0 sc1
    v_mul_f32 v136, v136, v224
    v_mul_f32 v137, v137, v224
    v_mul_f32 v138, v138, v224
    v_mul_f32 v139, v139, v224
    v_mul_f32 v140, v140, v224
    v_mul_f32 v141, v141, v224
    v_mul_f32 v142, v142, v224
    v_mul_f32 v143, v143, v224
    v_cvt_pk_bf16_f32 v148, v136, v137
    v_cvt_pk_bf16_f32 v149, v138, v139
    v_cvt_pk_bf16_f32 v150, v140, v141
    v_cvt_pk_bf16_f32 v151, v142, v143
    buffer_store_dwordx4 v[148:151], v227, s[28:31], s46 offen offset:1024 sc1
    s_add_u32 s46, s46, 8192
    s_add_u32 s61, s61, 1
    s_sub_u32 s6, s46, 57344
    s_cmp_lt_u32 s61, 7
    s_cselect_b32 s46, s46, s6
    s_cselect_b32 s61, s61, 0
    s_waitcnt vmcnt(9)
    s_call_b64 s[40:41], L_flag
    s_waitcnt vmcnt(7)
    s_call_b64 s[40:41], L_flag
    s_waitcnt vmcnt(5)
    s_call_b64 s[40:41], L_flag
    s_waitcnt vmcnt(3)
    s_call_b64 s[40:41], L_flag
    s_endpgm
L_flag:
    v_readfirstlane_b32 s6, v239
    s_nop 0
    s_and_b32 s6, s6, 0xffff
    s_cmp_ge_u32 s6, 16
    s_cbranch_scc1 L_flag_ok
    s_mov_b32 s7, 0
L_hs:
    buffer_load_dword v239, v238, s[48:51], 0 offen sc1
    s_add_u32 s7, s7, 1
    s_waitcnt vmcnt(0)
    v_readfirstlane_b32 s6, v239
    s_nop 0
    s_and_b32 s6, s6, 0xffff
    s_cmp_gt_u32 s7, 100000
    s_cbranch_scc1 L_flag_ok
    s_cmp_lt_u32 s6, 16
    s_cbranch_scc1 L_hs
L_flag_ok:
    s_mov_b64 exec, 1
    buffer_store_dword v229, v228, s[56:59], s36 offen sc1
    s_mov_b64 exec, -1
    s_add_u32 s36, s36, 512
    s_add_u32 s60, s60, 1
    s_cmp_lt_u32 s60, 7
    s_cselect_b32 s36, s36, 0
    s_cselect_b32 s60, s60, 0
    s_setpc_b64 s[40:41]
L_rescA:
    v_mov_b32 v233, v232
    s_nop 1
    v_permlane32_swap_b32 v233, v232
    v_max3_f32 v218, v232, v233, v225
    v_mul_f32 v222, s39, v218
    s_branch L_rescAret
L_rescB:
    v_sub_f32 v233, v225, v232
    v_sub_f32 v234, v218, v232
    v_sub_f32 v235, v220, v232
    v_mul_f32 v233, s39, v233
    v_mul_f32 v234, s39, v234
    v_mul_f32 v235, s39, v235
    v_exp_f32 v233, v233
    v_exp_f32 v234, v234
    v_exp_f32 v235, v235
    v_mov_b32 v225, v232
    v_mov_b32 v218, v232
    v_mul_f32 v222, s39, v232
    v_add_f32 v223, 0x42b17218, v232
    v_mul_f32 v224, v224, v233
    v_fma_f32 v224, v219, v234, v224
    v_fma_f32 v224, v221, v235, v224
    v_mul_f32 v0, v0, v233
    v_mul_f32 v1, v1, v233
    v_mul_f32 v2, v2, v233
    v_mul_f32 v3, v3, v233
    v_mul_f32 v4, v4, v233
    v_mul_f32 v5, v5, v233
    v_mul_f32 v6, v6, v233
    v_mul_f32 v7, v7, v233
    v_mul_f32 v8, v8, v233
    v_mul_f32 v9, v9, v233
    v_mul_f32 v10, v10, v233
    v_mul_f32 v11, v11, v233
    v_mul_f32 v12, v12, v233
    v_mul_f32 v13, v13, v233
    v_mul_f32 v14, v14, v233
    v_mul_f32 v15, v15, v233
    v_mul_f32 v16, v16, v233
    v_mul_f32 v17, v17, v233
    v_mul_f32 v18, v18, v233
    v_mul_f32 v19, v19, v233
    v_mul_f32 v20, v20, v233
    v_mul_f32 v21, v21, v233
    v_mul_f32 v22, v22, v233
    v_mul_f32 v23, v23, v233
    v_mul_f32 v24, v24, v233
    v_mul_f32 v25, v25, v233
    v_mul_f32 v26, v26, v233
    v_mul_f32 v27, v27, v233
    v_mul_f32 v28, v28, v233
    v_mul_f32 v29, v29, v233
    v_mul_f32 v30, v30, v233
    v_mul_f32 v31, v31, v233
    v_mul_f32 v32, v32, v233
    v_mul_f32 v33, v33, v233
    v_mul_f32 v34, v34, v233
    v_mul_f32 v35, v35, v233
    v_mul_f32 v36, v36, v233
    v_mul_f32 v37, v37, v233
    v_mul_f32 v38, v38, v233
    v_mul_f32 v39, v39, v233
    v_mul_f32 v40, v40, v233
    v_mul_f32 v41, v41, v233
    v_mul_f32 v42, v42, v233
    v_mul_f32 v43, v43, v233
    v_mul_f32 v44, v44, v233
    v_mul_f32 v45, v45, v233
    v_mul_f32 v46, v46, v233
    v_mul_f32 v47, v47, v233
    v_mul_f32 v48, v48, v233
    v_mul_f32 v49, v49, v233
    v_mul_f32 v50, v50, v233
    v_mul_f32 v51, v51, v233
    v_mul_f32 v52, v52, v233
    v_mul_f32 v53, v53, v233
    v_mul_f32 v54, v54, v233
    v_mul_f32 v55, v55, v233
    v_mul_f32 v56, v56, v233
    v_mul_f32 v57, v57, v233
    v_mul_f32 v58, v58, v233
    v_mul_f32 v59, v59, v233
    v_mul_f32 v60, v60, v233
    v_mul_f32 v61, v61, v233
    v_mul_f32 v62, v62, v233
    v_mul_f32 v63, v63, v233
    v_lshlrev_b32 v236, 16, v144
    v_and_b32 v237, 0xffff0000, v144
    v_mul_f32 v236, v236, v234
    v_mul_f32 v237, v237, v234
    v_cvt_pk_bf16_f32 v144, v236, v237
    v_lshlrev_b32 v236, 16, v145
    v_and_b32 v237, 0xffff0000, v145
    v_mul_f32 v236, v236, v234
    v_mul_f32 v237, v237, v234
    v_cvt_pk_bf16_f32 v145, v236, v237
    v_lshlrev_b32 v236, 16, v146
    v_and_b32 v237, 0xffff0000, v146
    v_mul_f32 v236, v236, v234
    v_mul_f32 v237, v237, v234
    v_cvt_pk_bf16_f32 v146, v236, v237
    v_lshlrev_b32 v236, 16, v147
    v_and_b32 v237, 0xffff0000, v147
    v_mul_f32 v236, v236, v234
    v_mul_f32 v237, v237, v234
    v_cvt_pk_bf16_f32 v147, v236, v237
    v_lshlrev_b32 v236, 16, v148
    v_and_b32 v237, 0xffff0000, v148
    v_mul_f32 v236, v236, v234
    v_mul_f32 v237, v237, v234
    v_cvt_pk_bf16_f32 v148, v236, v237
    v_lshlrev_b32 v236, 16, v149
    v_and_b32 v237, 0xffff0000, v149
    v_mul_f32 v236, v236, v234
    v_mul_f32 v237, v237, v234
    v_cvt_pk_bf16_f32 v149, v236, v237
    v_lshlrev_b32 v236, 16, v150
    v_and_b32 v237, 0xffff0000, v150
    v_mul_f32 v236, v236, v234
    v_mul_f32 v237, v237, v234
    v_cvt_pk_bf16_f32 v150, v236, v237
    v_lshlrev_b32 v236, 16, v151
    v_and_b32 v237, 0xffff0000, v151
    v_mul_f32 v236, v236, v234
    v_mul_f32 v237, v237, v234
    v_cvt_pk_bf16_f32 v151, v236, v237
    v_lshlrev_b32 v236, 16, v152
    v_and_b32 v237, 0xffff0000, v152
    v_mul_f32 v236, v236, v235
    v_mul_f32 v237, v237, v235
    v_cvt_pk_bf16_f32 v152, v236, v237
    v_lshlrev_b32 v236, 16, v153
    v_and_b32 v237, 0xffff0000, v153
    v_mul_f32 v236, v236, v235
    v_mul_f32 v237, v237, v235
    v_cvt_pk_bf16_f32 v153, v236, v237
    v_lshlrev_b32 v236, 16, v154
    v_and_b32 v237, 0xffff0000, v154
    v_mul_f32 v236, v236, v235
    v_mul_f32 v237, v237, v235
    v_cvt_pk_bf16_f32 v154, v236, v237
    v_lshlrev_b32 v236, 16, v155
    v_and_b32 v237, 0xffff0000, v155
    v_mul_f32 v236, v236, v235
    v_mul_f32 v237, v237, v235
    v_cvt_pk_bf16_f32 v155, v236, v237
    v_lshlrev_b32 v236, 16, v156
    v_and_b32 v237, 0xffff0000, v156
    v_mul_f32 v236, v236, v235
    v_mul_f32 v237, v237, v235
    v_cvt_pk_bf16_f32 v156, v236, v237
    v_lshlrev_b32 v236, 16, v157
    v_and_b32 v237, 0xffff0000, v157
    v_mul_f32 v236, v236, v235
    v_mul_f32 v237, v237, v235
    v_cvt_pk_bf16_f32 v157, v236, v237
    v_lshlrev_b32 v236, 16, v158
    v_and_b32 v237, 0xffff0000, v158
    v_mul_f32 v236, v236, v235
    v_mul_f32 v237, v237, v235
    v_cvt_pk_bf16_f32 v158, v236, v237
    v_lshlrev_b32 v236, 16, v159
    v_and_b32 v237, 0xffff0000, v159
    v_mul_f32 v236, v236, v235
    v_mul_f32 v237, v237, v235
    v_cvt_pk_bf16_f32 v159, v236, v237
    s_branch L_rescBret
L_codeend:
.section .rodata,"a"
.p2align 6
.amdhsa_kernel concat_heads__gqa_block_cached__gqa_block_cached__near_ridge_kernel
.amdhsa_next_free_vgpr 256
.amdhsa_next_free_sgpr 102
.amdhsa_accum_offset 256
.amdhsa_group_segment_fixed_size 0
.amdhsa_kernarg_size 104
.amdhsa_user_sgpr_count 2
.amdhsa_user_sgpr_kernarg_segment_ptr 1
.amdhsa_system_sgpr_workgroup_id_x 1
.end_amdhsa_kernel
```
